```python
import torch

def _softmax(x, axis=-1):
    return torch.softmax(x, dim=axis)
def _gelu(x):
    return torch.nn.functional.gelu(x, approximate="tanh")
def _silu(x):
    return torch.nn.functional.silu(x)
def _sigmoid(x):
    return torch.sigmoid(x)
def _layernorm(x, axis=-1, eps=1e-5):
    m = x.mean(dim=axis, keepdim=True)
    v = x.var(dim=axis, keepdim=True, unbiased=False)
    return (x - m) / torch.sqrt(v + eps)
def _scatter_add(tgt, idx, src, axis=0):
    return tgt.clone().index_add_(axis, idx, src)
def _segment_sum(src, seg, n):
    out = torch.zeros((n,) + src.shape[1:], dtype=src.dtype)
    return out.index_add_(0, seg, src)
def _pad(x, pw):
    flat = tuple(v for pair in reversed(pw) for v in pair)
    return torch.nn.functional.pad(x, flat)

kernel_name = 'recurrent_scan__gqa_block_cached__dense_activation_gelu__decode'

def setup_inputs():

    _w = (lambda a: (lambda t: t.to(torch.bfloat16) if t.is_floating_point() else t)(torch.as_tensor(a)))
    def _A_setup():
        B, Sq, D = 8, 1, 512
        Hq, Hkv, Sk, Dh = 32, 8, 4096, 128
        assert Hq % Hkv == 0, (Hq, Hkv)
        return {
            "x": _w((lambda *s: torch.randn(*s, dtype=torch.bfloat16) * 0.05)(B, Sq, D)),
            "k_cache": _w((lambda *s: torch.randn(*s, dtype=torch.bfloat16) * 3.2)(B, Hkv, Sk, Dh)),
            "v_cache": _w((lambda *s: torch.randn(*s, dtype=torch.bfloat16) * 3.2)(B, Hkv, Sk, Dh)),
            "wq": _w((lambda *s: torch.randn(*s, dtype=torch.bfloat16) * 3.2)(D, Hq * Dh) * (D ** -0.5)),
            "wo": _w((lambda *s: torch.randn(*s, dtype=torch.bfloat16) * 3.2)(Hq * Dh, D) * ((Hq * Dh) ** -0.5)),
        }
    _A_in = _A_setup()

    def _B_setup():
        B, S, D, F = 8, 1, 512, 1792
        return {
            "x": _w((lambda *s: torch.randn(*s, dtype=torch.bfloat16) * 0.05)(B, S, D)),
            "w1": _w((lambda *s: torch.randn(*s, dtype=torch.bfloat16) * 3.2)(D, F) * (D ** -0.5)),
            "b1": _w((lambda *s: torch.randn(*s, dtype=torch.bfloat16) * 3.2)(F) * 0.01),
            "w2": _w((lambda *s: torch.randn(*s, dtype=torch.bfloat16) * 0.4)(F, D) * (F ** -0.5)),
            "b2": _w((lambda *s: torch.randn(*s, dtype=torch.bfloat16) * 0.4)(D) * 0.01),
        }
    _B_in = _B_setup()

    return {
        "A_x": _A_in["x"],
        "A_k_cache": _A_in["k_cache"],
        "A_v_cache": _A_in["v_cache"],
        "A_wq": _A_in["wq"],
        "A_wo": _A_in["wo"],
        "B_x": _B_in["x"],
        "B_w1": _B_in["w1"],
        "B_b1": _B_in["b1"],
        "B_w2": _B_in["w2"],
        "B_b2": _B_in["b2"],
    }

def reference(A_x, A_k_cache, A_v_cache, A_wq, A_wo, B_x, B_w1, B_b1, B_w2, B_b2):
    def _A_ref(x, k_cache, v_cache, wq, wo):
        B, Sq, D = x.shape
        Hq, Dh = 32, 128
        Hkv = k_cache.shape[1]
        rep = Hq // Hkv
        q = (lambda x, *d: x.permute(*d))((x @ wq).reshape(B, Sq, Hq, Dh), 0, 2, 1, 3)
        k = (lambda x, n, axis: torch.repeat_interleave(x, n, dim=axis))(k_cache, rep, axis=1)
        v = (lambda x, n, axis: torch.repeat_interleave(x, n, dim=axis))(v_cache, rep, axis=1)
        scores = torch.einsum("bhqd,bhkd->bhqk", q, k) * (Dh ** -0.5)
        p = _softmax(scores, axis=-1)
        o = torch.einsum("bhqk,bhkd->bhqd", p, v)
        return (lambda x, *d: x.permute(*d))(o, 0, 2, 1, 3).reshape(B, Sq, Hq * Dh) @ wo

    def _B_ref(x, w1, b1, w2, b2):
        h = torch.einsum("bsd,df->bsf", x, w1) + b1
        h = _gelu(h)
        return torch.einsum("bsf,fd->bsd", h, w2) + b2

    x = A_x
    xn = _layernorm(x, axis=-1)
    s = _A_ref(xn, A_k_cache, A_v_cache, A_wq, A_wo)
    g = _silu(_B_ref(xn, B_w1, B_b1, B_w2, B_b2))
    return x + s * g
```

```asm
; @launch kernel=recurrent_scan__gqa_block_cached__dense_activation_gelu__decode_k1_kernel grid=(184,1,1) block=(256,1,1) lds=24576
; @launch kernel=recurrent_scan__gqa_block_cached__dense_activation_gelu__decode_k2_kernel grid=(512,1,1) block=(256,1,1) lds=9472
; @launch kernel=recurrent_scan__gqa_block_cached__dense_activation_gelu__decode_k3_kernel grid=(184,1,1) block=(256,1,1) lds=24576
; @launch kernel=recurrent_scan__gqa_block_cached__dense_activation_gelu__decode_k4_kernel grid=(16,1,1) block=(256,1,1) lds=0
.amdgcn_target "amdgcn-amd-amdhsa--gfx950"
.text
.globl recurrent_scan__gqa_block_cached__dense_activation_gelu__decode_k1_kernel
.p2align 8
.type recurrent_scan__gqa_block_cached__dense_activation_gelu__decode_k1_kernel,@function
recurrent_scan__gqa_block_cached__dense_activation_gelu__decode_k1_kernel:
    s_cmp_ge_u32 s2, 184
    s_cbranch_scc1 K1_done
    s_load_dwordx2 s[4:5], s[0:1], 0
    s_load_dwordx2 s[6:7], s[0:1], 24
    s_load_dwordx2 s[10:11], s[0:1], 48
    s_load_dwordx2 s[8:9], s[0:1], 96
    v_lshrrev_b32 v1, 6, v0
    v_and_b32 v2, 63, v0
    s_nop 0
    v_readfirstlane_b32 s3, v1
    s_waitcnt lgkmcnt(0)
    s_mov_b32 s12, s4
    s_mov_b32 s13, s5
    s_mov_b32 s14, 0x2000
    s_mov_b32 s15, 0x00020000
    s_mov_b32 s20, s8
    s_mov_b32 s21, s9
    s_mov_b32 s22, 0x210000
    s_mov_b32 s23, 0x00020000
    s_lshl_b32 s24, s3, 11
    v_lshlrev_b32 v3, 4, v2
    buffer_load_dwordx4 v[8:11], v3, s[12:15], s24 offen
    buffer_load_dwordx4 v[12:15], v3, s[12:15], s24 offen offset:1024
    s_cmp_ge_u32 s2, 128
    s_cbranch_scc1 K1_hsel
    s_mov_b32 s16, s6
    s_mov_b32 s17, s7
    s_mov_b32 s18, 0x400000
    s_mov_b32 s19, 0x00020000
    s_mov_b32 s25, s2
    s_mov_b32 s26, 8192
    s_branch K1_sel_done
K1_hsel:
    s_mov_b32 s16, s10
    s_mov_b32 s17, s11
    s_mov_b32 s18, 0x1c0000
    s_mov_b32 s19, 0x00020000
    s_sub_u32 s25, s2, 128
    s_mov_b32 s26, 3584
K1_sel_done:
    s_lshr_b32 s27, s25, 2
    s_and_b32 s28, s25, 3
    s_lshl_b32 s29, s28, 7
    s_lshl_b32 s30, s3, 5
    s_add_u32 s29, s29, s30
    s_mul_i32 s30, s29, s26
    s_lshl_b32 s31, s27, 8
    s_add_u32 s30, s30, s31
    v_lshrrev_b32 v4, 4, v2
    v_lshlrev_b32 v4, 3, v4
    v_mul_lo_u32 v4, v4, s26
    v_and_b32 v5, 15, v2
    v_lshlrev_b32 v5, 4, v5
    v_add_u32 v4, v4, v5
    buffer_load_dwordx4 v[32:35], v4, s[16:19], s30 offen
    s_add_u32 s30, s30, s26
    buffer_load_dwordx4 v[36:39], v4, s[16:19], s30 offen
    s_add_u32 s30, s30, s26
    buffer_load_dwordx4 v[40:43], v4, s[16:19], s30 offen
    s_add_u32 s30, s30, s26
    buffer_load_dwordx4 v[44:47], v4, s[16:19], s30 offen
    s_add_u32 s30, s30, s26
    buffer_load_dwordx4 v[48:51], v4, s[16:19], s30 offen
    s_add_u32 s30, s30, s26
    buffer_load_dwordx4 v[52:55], v4, s[16:19], s30 offen
    s_add_u32 s30, s30, s26
    buffer_load_dwordx4 v[56:59], v4, s[16:19], s30 offen
    s_add_u32 s30, s30, s26
    buffer_load_dwordx4 v[60:63], v4, s[16:19], s30 offen
    s_cmp_ge_u32 s2, 8
    s_cbranch_scc1 K1_nozero
    v_mov_b32 v64, 0
    v_mov_b32 v65, 0
    v_mov_b32 v66, 0
    v_mov_b32 v67, 0
    s_lshl_b32 s31, s2, 12
    s_add_u32 s31, s31, 0xc0000
    v_lshlrev_b32 v5, 4, v0
    buffer_store_dwordx4 v[64:67], v5, s[20:23], s31 offen
K1_nozero:
    s_waitcnt vmcnt(8)
    v_lshlrev_b32 v97, 4, v2
    v_mov_b32 v98, s24
    v_add_u32 v97, v97, v98
    s_waitcnt vmcnt(8)
    s_cmp_ge_u32 s2, 8
    s_cbranch_scc1 K1_w_ok
    s_waitcnt vmcnt(9)
K1_w_ok:
    v_lshlrev_b32 v72, 16, v8
    v_and_b32 v73, 0xffff0000, v8
    v_lshlrev_b32 v74, 16, v9
    v_and_b32 v75, 0xffff0000, v9
    v_lshlrev_b32 v76, 16, v10
    v_and_b32 v77, 0xffff0000, v10
    v_lshlrev_b32 v78, 16, v11
    v_and_b32 v79, 0xffff0000, v11
    v_add_f32 v90, v72, v73
    v_add_f32 v90, v90, v74
    v_add_f32 v90, v90, v75
    v_add_f32 v90, v90, v76
    v_add_f32 v90, v90, v77
    v_add_f32 v90, v90, v78
    v_add_f32 v90, v90, v79
    s_nop 1
    v_add_f32_dpp v90, v90, v90 quad_perm:[1,0,3,2] row_mask:0xf bank_mask:0xf
    s_nop 1
    v_add_f32_dpp v90, v90, v90 quad_perm:[2,3,0,1] row_mask:0xf bank_mask:0xf
    s_nop 1
    v_add_f32_dpp v90, v90, v90 row_half_mirror row_mask:0xf bank_mask:0xf
    s_nop 1
    v_add_f32_dpp v90, v90, v90 row_mirror row_mask:0xf bank_mask:0xf
    s_nop 1
    v_readlane_b32 s40, v90, 0
    v_readlane_b32 s41, v90, 16
    v_readlane_b32 s42, v90, 32
    v_readlane_b32 s43, v90, 48
    s_nop 1
    v_mov_b32 v90, s40
    v_add_f32 v90, s41, v90
    v_add_f32 v90, s42, v90
    v_add_f32 v90, s43, v90
    v_mul_f32 v90, 0x3b000000, v90
    v_mov_b32 v91, 0
    v_sub_f32 v92, v72, v90
    v_fmac_f32 v91, v92, v92
    v_sub_f32 v92, v73, v90
    v_fmac_f32 v91, v92, v92
    v_sub_f32 v92, v74, v90
    v_fmac_f32 v91, v92, v92
    v_sub_f32 v92, v75, v90
    v_fmac_f32 v91, v92, v92
    v_sub_f32 v92, v76, v90
    v_fmac_f32 v91, v92, v92
    v_sub_f32 v92, v77, v90
    v_fmac_f32 v91, v92, v92
    v_sub_f32 v92, v78, v90
    v_fmac_f32 v91, v92, v92
    v_sub_f32 v92, v79, v90
    v_fmac_f32 v91, v92, v92
    s_nop 1
    v_add_f32_dpp v91, v91, v91 quad_perm:[1,0,3,2] row_mask:0xf bank_mask:0xf
    s_nop 1
    v_add_f32_dpp v91, v91, v91 quad_perm:[2,3,0,1] row_mask:0xf bank_mask:0xf
    s_nop 1
    v_add_f32_dpp v91, v91, v91 row_half_mirror row_mask:0xf bank_mask:0xf
    s_nop 1
    v_add_f32_dpp v91, v91, v91 row_mirror row_mask:0xf bank_mask:0xf
    s_nop 1
    v_readlane_b32 s40, v91, 0
    v_readlane_b32 s41, v91, 16
    v_readlane_b32 s42, v91, 32
    v_readlane_b32 s43, v91, 48
    s_nop 1
    v_mov_b32 v91, s40
    v_add_f32 v91, s41, v91
    v_add_f32 v91, s42, v91
    v_add_f32 v91, s43, v91
    v_mul_f32 v91, 0x3b000000, v91
    v_cvt_pk_bf16_f32 v90, v90, v90
    v_lshlrev_b32 v90, 16, v90
    v_cvt_pk_bf16_f32 v91, v91, v91
    v_lshlrev_b32 v91, 16, v91
    v_add_f32 v91, 0x3727c5ac, v91
    v_cvt_pk_bf16_f32 v91, v91, v91
    v_lshlrev_b32 v91, 16, v91
    v_sqrt_f32 v91, v91
    s_nop 0
    v_cvt_pk_bf16_f32 v91, v91, v91
    v_lshlrev_b32 v91, 16, v91
    v_rcp_f32 v93, v91
    s_nop 0
    v_fma_f32 v94, -v91, v93, 1.0
    v_fma_f32 v93, v94, v93, v93
    v_sub_f32 v92, v72, v90
    v_cvt_pk_bf16_f32 v92, v92, v92
    v_lshlrev_b32 v92, 16, v92
    v_mul_f32 v95, v92, v93
    v_fma_f32 v96, -v95, v91, v92
    v_fma_f32 v72, v96, v93, v95
    v_sub_f32 v92, v73, v90
    v_cvt_pk_bf16_f32 v92, v92, v92
    v_lshlrev_b32 v92, 16, v92
    v_mul_f32 v95, v92, v93
    v_fma_f32 v96, -v95, v91, v92
    v_fma_f32 v73, v96, v93, v95
    v_sub_f32 v92, v74, v90
    v_cvt_pk_bf16_f32 v92, v92, v92
    v_lshlrev_b32 v92, 16, v92
    v_mul_f32 v95, v92, v93
    v_fma_f32 v96, -v95, v91, v92
    v_fma_f32 v74, v96, v93, v95
    v_sub_f32 v92, v75, v90
    v_cvt_pk_bf16_f32 v92, v92, v92
    v_lshlrev_b32 v92, 16, v92
    v_mul_f32 v95, v92, v93
    v_fma_f32 v96, -v95, v91, v92
    v_fma_f32 v75, v96, v93, v95
    v_sub_f32 v92, v76, v90
    v_cvt_pk_bf16_f32 v92, v92, v92
    v_lshlrev_b32 v92, 16, v92
    v_mul_f32 v95, v92, v93
    v_fma_f32 v96, -v95, v91, v92
    v_fma_f32 v76, v96, v93, v95
    v_sub_f32 v92, v77, v90
    v_cvt_pk_bf16_f32 v92, v92, v92
    v_lshlrev_b32 v92, 16, v92
    v_mul_f32 v95, v92, v93
    v_fma_f32 v96, -v95, v91, v92
    v_fma_f32 v77, v96, v93, v95
    v_sub_f32 v92, v78, v90
    v_cvt_pk_bf16_f32 v92, v92, v92
    v_lshlrev_b32 v92, 16, v92
    v_mul_f32 v95, v92, v93
    v_fma_f32 v96, -v95, v91, v92
    v_fma_f32 v78, v96, v93, v95
    v_sub_f32 v92, v79, v90
    v_cvt_pk_bf16_f32 v92, v92, v92
    v_lshlrev_b32 v92, 16, v92
    v_mul_f32 v95, v92, v93
    v_fma_f32 v96, -v95, v91, v92
    v_fma_f32 v79, v96, v93, v95
    v_cvt_pk_bf16_f32 v8, v72, v73
    v_cvt_pk_bf16_f32 v9, v74, v75
    v_cvt_pk_bf16_f32 v10, v76, v77
    v_cvt_pk_bf16_f32 v11, v78, v79
    s_nop 0
    ds_write_b128 v97, v[8:11] offset:0
    v_lshlrev_b32 v80, 16, v12
    v_and_b32 v81, 0xffff0000, v12
    v_lshlrev_b32 v82, 16, v13
    v_and_b32 v83, 0xffff0000, v13
    v_lshlrev_b32 v84, 16, v14
    v_and_b32 v85, 0xffff0000, v14
    v_lshlrev_b32 v86, 16, v15
    v_and_b32 v87, 0xffff0000, v15
    v_add_f32 v90, v80, v81
    v_add_f32 v90, v90, v82
    v_add_f32 v90, v90, v83
    v_add_f32 v90, v90, v84
    v_add_f32 v90, v90, v85
    v_add_f32 v90, v90, v86
    v_add_f32 v90, v90, v87
    s_nop 1
    v_add_f32_dpp v90, v90, v90 quad_perm:[1,0,3,2] row_mask:0xf bank_mask:0xf
    s_nop 1
    v_add_f32_dpp v90, v90, v90 quad_perm:[2,3,0,1] row_mask:0xf bank_mask:0xf
    s_nop 1
    v_add_f32_dpp v90, v90, v90 row_half_mirror row_mask:0xf bank_mask:0xf
    s_nop 1
    v_add_f32_dpp v90, v90, v90 row_mirror row_mask:0xf bank_mask:0xf
    s_nop 1
    v_readlane_b32 s40, v90, 0
    v_readlane_b32 s41, v90, 16
    v_readlane_b32 s42, v90, 32
    v_readlane_b32 s43, v90, 48
    s_nop 1
    v_mov_b32 v90, s40
    v_add_f32 v90, s41, v90
    v_add_f32 v90, s42, v90
    v_add_f32 v90, s43, v90
    v_mul_f32 v90, 0x3b000000, v90
    v_mov_b32 v91, 0
    v_sub_f32 v92, v80, v90
    v_fmac_f32 v91, v92, v92
    v_sub_f32 v92, v81, v90
    v_fmac_f32 v91, v92, v92
    v_sub_f32 v92, v82, v90
    v_fmac_f32 v91, v92, v92
    v_sub_f32 v92, v83, v90
    v_fmac_f32 v91, v92, v92
    v_sub_f32 v92, v84, v90
    v_fmac_f32 v91, v92, v92
    v_sub_f32 v92, v85, v90
    v_fmac_f32 v91, v92, v92
    v_sub_f32 v92, v86, v90
    v_fmac_f32 v91, v92, v92
    v_sub_f32 v92, v87, v90
    v_fmac_f32 v91, v92, v92
    s_nop 1
    v_add_f32_dpp v91, v91, v91 quad_perm:[1,0,3,2] row_mask:0xf bank_mask:0xf
    s_nop 1
    v_add_f32_dpp v91, v91, v91 quad_perm:[2,3,0,1] row_mask:0xf bank_mask:0xf
    s_nop 1
    v_add_f32_dpp v91, v91, v91 row_half_mirror row_mask:0xf bank_mask:0xf
    s_nop 1
    v_add_f32_dpp v91, v91, v91 row_mirror row_mask:0xf bank_mask:0xf
    s_nop 1
    v_readlane_b32 s40, v91, 0
    v_readlane_b32 s41, v91, 16
    v_readlane_b32 s42, v91, 32
    v_readlane_b32 s43, v91, 48
    s_nop 1
    v_mov_b32 v91, s40
    v_add_f32 v91, s41, v91
    v_add_f32 v91, s42, v91
    v_add_f32 v91, s43, v91
    v_mul_f32 v91, 0x3b000000, v91
    v_cvt_pk_bf16_f32 v90, v90, v90
    v_lshlrev_b32 v90, 16, v90
    v_cvt_pk_bf16_f32 v91, v91, v91
    v_lshlrev_b32 v91, 16, v91
    v_add_f32 v91, 0x3727c5ac, v91
    v_cvt_pk_bf16_f32 v91, v91, v91
    v_lshlrev_b32 v91, 16, v91
    v_sqrt_f32 v91, v91
    s_nop 0
    v_cvt_pk_bf16_f32 v91, v91, v91
    v_lshlrev_b32 v91, 16, v91
    v_rcp_f32 v93, v91
    s_nop 0
    v_fma_f32 v94, -v91, v93, 1.0
    v_fma_f32 v93, v94, v93, v93
    v_sub_f32 v92, v80, v90
    v_cvt_pk_bf16_f32 v92, v92, v92
    v_lshlrev_b32 v92, 16, v92
    v_mul_f32 v95, v92, v93
    v_fma_f32 v96, -v95, v91, v92
    v_fma_f32 v80, v96, v93, v95
    v_sub_f32 v92, v81, v90
    v_cvt_pk_bf16_f32 v92, v92, v92
    v_lshlrev_b32 v92, 16, v92
    v_mul_f32 v95, v92, v93
    v_fma_f32 v96, -v95, v91, v92
    v_fma_f32 v81, v96, v93, v95
    v_sub_f32 v92, v82, v90
    v_cvt_pk_bf16_f32 v92, v92, v92
    v_lshlrev_b32 v92, 16, v92
    v_mul_f32 v95, v92, v93
    v_fma_f32 v96, -v95, v91, v92
    v_fma_f32 v82, v96, v93, v95
    v_sub_f32 v92, v83, v90
    v_cvt_pk_bf16_f32 v92, v92, v92
    v_lshlrev_b32 v92, 16, v92
    v_mul_f32 v95, v92, v93
    v_fma_f32 v96, -v95, v91, v92
    v_fma_f32 v83, v96, v93, v95
    v_sub_f32 v92, v84, v90
    v_cvt_pk_bf16_f32 v92, v92, v92
    v_lshlrev_b32 v92, 16, v92
    v_mul_f32 v95, v92, v93
    v_fma_f32 v96, -v95, v91, v92
    v_fma_f32 v84, v96, v93, v95
    v_sub_f32 v92, v85, v90
    v_cvt_pk_bf16_f32 v92, v92, v92
    v_lshlrev_b32 v92, 16, v92
    v_mul_f32 v95, v92, v93
    v_fma_f32 v96, -v95, v91, v92
    v_fma_f32 v85, v96, v93, v95
    v_sub_f32 v92, v86, v90
    v_cvt_pk_bf16_f32 v92, v92, v92
    v_lshlrev_b32 v92, 16, v92
    v_mul_f32 v95, v92, v93
    v_fma_f32 v96, -v95, v91, v92
    v_fma_f32 v86, v96, v93, v95
    v_sub_f32 v92, v87, v90
    v_cvt_pk_bf16_f32 v92, v92, v92
    v_lshlrev_b32 v92, 16, v92
    v_mul_f32 v95, v92, v93
    v_fma_f32 v96, -v95, v91, v92
    v_fma_f32 v87, v96, v93, v95
    v_cvt_pk_bf16_f32 v12, v80, v81
    v_cvt_pk_bf16_f32 v13, v82, v83
    v_cvt_pk_bf16_f32 v14, v84, v85
    v_cvt_pk_bf16_f32 v15, v86, v87
    s_nop 0
    ds_write_b128 v97, v[12:15] offset:1024
    s_waitcnt lgkmcnt(0)
    s_barrier
    v_and_b32 v5, 7, v2
    v_lshlrev_b32 v5, 10, v5
    v_lshrrev_b32 v6, 4, v2
    v_lshlrev_b32 v6, 4, v6
    v_add_u32 v5, v5, v6
    s_lshl_b32 s31, s29, 1
    v_add_u32 v5, s31, v5
    ds_read_b128 v[8:11], v5
    s_mov_b32 s32, 0x05040100
    s_mov_b32 s33, 0x07060302
    s_waitcnt vmcnt(0) lgkmcnt(0)
    v_perm_b32 v64, v36, v32, s32
    v_perm_b32 v65, v44, v40, s32
    v_perm_b32 v66, v52, v48, s32
    v_perm_b32 v67, v60, v56, s32
    v_perm_b32 v68, v36, v32, s33
    v_perm_b32 v69, v44, v40, s33
    v_perm_b32 v70, v52, v48, s33
    v_perm_b32 v71, v60, v56, s33
    v_perm_b32 v72, v37, v33, s32
    v_perm_b32 v73, v45, v41, s32
    v_perm_b32 v74, v53, v49, s32
    v_perm_b32 v75, v61, v57, s32
    v_perm_b32 v76, v37, v33, s33
    v_perm_b32 v77, v45, v41, s33
    v_perm_b32 v78, v53, v49, s33
    v_perm_b32 v79, v61, v57, s33
    v_perm_b32 v80, v38, v34, s32
    v_perm_b32 v81, v46, v42, s32
    v_perm_b32 v82, v54, v50, s32
    v_perm_b32 v83, v62, v58, s32
    v_perm_b32 v84, v38, v34, s33
    v_perm_b32 v85, v46, v42, s33
    v_perm_b32 v86, v54, v50, s33
    v_perm_b32 v87, v62, v58, s33
    v_perm_b32 v88, v39, v35, s32
    v_perm_b32 v89, v47, v43, s32
    v_perm_b32 v90, v55, v51, s32
    v_perm_b32 v91, v63, v59, s32
    v_perm_b32 v92, v39, v35, s33
    v_perm_b32 v93, v47, v43, s33
    v_perm_b32 v94, v55, v51, s33
    v_perm_b32 v95, v63, v59, s33
    s_nop 1
    v_mfma_f32_16x16x32_bf16 v[96:99], v[8:11], v[64:67], 0
    v_mfma_f32_16x16x32_bf16 v[100:103], v[8:11], v[68:71], 0
    v_mfma_f32_16x16x32_bf16 v[104:107], v[8:11], v[72:75], 0
    v_mfma_f32_16x16x32_bf16 v[108:111], v[8:11], v[76:79], 0
    v_mfma_f32_16x16x32_bf16 v[112:115], v[8:11], v[80:83], 0
    v_mfma_f32_16x16x32_bf16 v[116:119], v[8:11], v[84:87], 0
    v_mfma_f32_16x16x32_bf16 v[120:123], v[8:11], v[88:91], 0
    v_mfma_f32_16x16x32_bf16 v[124:127], v[8:11], v[92:95], 0
    s_nop 7
    s_nop 1
    v_lshrrev_b32 v5, 4, v2
    v_lshlrev_b32 v5, 11, v5
    v_and_b32 v6, 15, v2
    v_lshlrev_b32 v6, 5, v6
    v_add_u32 v5, v5, v6
    s_lshl_b32 s31, s3, 12
    s_add_u32 s31, s31, 8192
    v_add_u32 v5, s31, v5
    v_cmp_gt_u32 vcc, 32, v2
    s_and_saveexec_b64 s[34:35], vcc
    ds_write_b32 v5, v96 offset:0
    ds_write_b32 v5, v97 offset:512
    ds_write_b32 v5, v98 offset:1024
    ds_write_b32 v5, v99 offset:1536
    ds_write_b32 v5, v100 offset:4
    ds_write_b32 v5, v101 offset:516
    ds_write_b32 v5, v102 offset:1028
    ds_write_b32 v5, v103 offset:1540
    ds_write_b32 v5, v104 offset:8
    ds_write_b32 v5, v105 offset:520
    ds_write_b32 v5, v106 offset:1032
    ds_write_b32 v5, v107 offset:1544
    ds_write_b32 v5, v108 offset:12
    ds_write_b32 v5, v109 offset:524
    ds_write_b32 v5, v110 offset:1036
    ds_write_b32 v5, v111 offset:1548
    ds_write_b32 v5, v112 offset:16
    ds_write_b32 v5, v113 offset:528
    ds_write_b32 v5, v114 offset:1040
    ds_write_b32 v5, v115 offset:1552
    ds_write_b32 v5, v116 offset:20
    ds_write_b32 v5, v117 offset:532
    ds_write_b32 v5, v118 offset:1044
    ds_write_b32 v5, v119 offset:1556
    ds_write_b32 v5, v120 offset:24
    ds_write_b32 v5, v121 offset:536
    ds_write_b32 v5, v122 offset:1048
    ds_write_b32 v5, v123 offset:1560
    ds_write_b32 v5, v124 offset:28
    ds_write_b32 v5, v125 offset:540
    ds_write_b32 v5, v126 offset:1052
    ds_write_b32 v5, v127 offset:1564
    s_mov_b64 exec, s[34:35]
    s_waitcnt lgkmcnt(0)
    s_barrier
    v_lshlrev_b32 v5, 4, v0
    ds_read_b128 v[8:11], v5 offset:8192
    ds_read_b128 v[12:15], v5 offset:12288
    ds_read_b128 v[16:19], v5 offset:16384
    ds_read_b128 v[20:23], v5 offset:20480
    s_waitcnt lgkmcnt(0)
    v_add_f32 v8, v8, v12
    v_add_f32 v16, v16, v20
    v_add_f32 v8, v8, v16
    v_add_f32 v9, v9, v13
    v_add_f32 v17, v17, v21
    v_add_f32 v9, v9, v17
    v_add_f32 v10, v10, v14
    v_add_f32 v18, v18, v22
    v_add_f32 v10, v10, v18
    v_add_f32 v11, v11, v15
    v_add_f32 v19, v19, v23
    v_add_f32 v11, v11, v19
    s_cmp_ge_u32 s2, 128
    s_cbranch_scc1 K1_hst
    s_mov_b32 s36, 16384
    s_mov_b32 s37, 0x0
    s_branch K1_st
K1_hst:
    s_mov_b32 s36, 7168
    s_mov_b32 s37, 0x80000
K1_st:
    s_lshl_b32 s38, s36, 3
    s_mul_i32 s38, s38, s28
    s_add_u32 s37, s37, s38
    s_lshl_b32 s38, s27, 9
    s_add_u32 s37, s37, s38
    v_lshrrev_b32 v5, 5, v0
    v_mul_lo_u32 v5, v5, s36
    v_and_b32 v6, 31, v0
    v_lshlrev_b32 v6, 4, v6
    v_add_u32 v5, v5, v6
    buffer_store_dwordx4 v[8:11], v5, s[20:23], s37 offen
K1_done:
    s_endpgm
.globl recurrent_scan__gqa_block_cached__dense_activation_gelu__decode_k2_kernel
.p2align 8
.type recurrent_scan__gqa_block_cached__dense_activation_gelu__decode_k2_kernel,@function
recurrent_scan__gqa_block_cached__dense_activation_gelu__decode_k2_kernel:
    s_cmp_ge_u32 s2, 512
    s_cbranch_scc1 K2_done
    s_load_dwordx2 s[4:5], s[0:1], 8
    s_load_dwordx2 s[6:7], s[0:1], 16
    s_load_dwordx2 s[8:9], s[0:1], 96
    v_lshrrev_b32 v1, 6, v0
    v_and_b32 v2, 63, v0
    s_nop 0
    v_readfirstlane_b32 s3, v1
    s_waitcnt lgkmcnt(0)
    s_mov_b32 s12, s4
    s_mov_b32 s13, s5
    s_mov_b32 s14, 0x4000000
    s_mov_b32 s15, 0x00020000
    s_mov_b32 s16, s6
    s_mov_b32 s17, s7
    s_mov_b32 s18, 0x4000000
    s_mov_b32 s19, 0x00020000
    s_mov_b32 s20, s8
    s_mov_b32 s21, s9
    s_mov_b32 s22, 0x210000
    s_mov_b32 s23, 0x00020000
    s_lshr_b32 s24, s2, 3
    s_and_b32 s25, s2, 7
    s_lshl_b32 s26, s24, 20
    s_lshl_b32 s27, s25, 17
    s_add_u32 s26, s26, s27
    s_lshl_b32 s27, s3, 15
    s_add_u32 s26, s26, s27
    s_lshr_b32 s28, s24, 3
    s_and_b32 s29, s24, 7
    s_lshl_b32 s30, s28, 14
    s_lshl_b32 s31, s29, 11
    s_add_u32 s30, s30, s31
    v_lshlrev_b32 v3, 3, v0
    buffer_load_dwordx2 v[4:5], v3, s[20:23], s30 offen
    s_add_u32 s30, s30, 131072
    buffer_load_dwordx2 v[6:7], v3, s[20:23], s30 offen
    s_add_u32 s30, s30, 131072
    buffer_load_dwordx2 v[8:9], v3, s[20:23], s30 offen
    s_add_u32 s30, s30, 131072
    buffer_load_dwordx2 v[10:11], v3, s[20:23], s30 offen
    v_and_b32 v12, 15, v2
    v_lshrrev_b32 v13, 4, v2
    v_lshlrev_b32 v14, 8, v12
    v_lshl_add_u32 v14, v13, 4, v14
    s_mul_i32 s45, s3, 4352
    s_add_u32 s45, s45, 10240
    v_mul_u32_u24 v96, 272, v13
    v_lshl_add_u32 v96, v12, 4, v96
    v_add_u32 v96, s45, v96
    v_mul_u32_u24 v97, 272, v12
    v_lshl_add_u32 v97, v13, 4, v97
    v_add_u32 v97, s45, v97
    v_lshlrev_b32 v15, 10, v13
    v_lshl_add_u32 v15, v12, 4, v15
    s_mov_b32 s32, s26
    s_mov_b32 s33, s26
    s_add_u32 s34, s26, 4096
    buffer_load_dwordx4 v[100:103], v14, s[12:15], s32 offen offset:0 nt
    buffer_load_dwordx4 v[104:107], v14, s[12:15], s32 offen offset:64 nt
    buffer_load_dwordx4 v[108:111], v14, s[12:15], s32 offen offset:128 nt
    buffer_load_dwordx4 v[112:115], v14, s[12:15], s32 offen offset:192 nt
    s_add_u32 s32, s32, 4096
    buffer_load_dwordx4 v[116:119], v14, s[12:15], s32 offen offset:0 nt
    buffer_load_dwordx4 v[120:123], v14, s[12:15], s32 offen offset:64 nt
    buffer_load_dwordx4 v[124:127], v14, s[12:15], s32 offen offset:128 nt
    buffer_load_dwordx4 v[128:131], v14, s[12:15], s32 offen offset:192 nt
    s_add_u32 s32, s32, 4096
    buffer_load_dwordx4 v[132:135], v14, s[12:15], s32 offen offset:0 nt
    buffer_load_dwordx4 v[136:139], v14, s[12:15], s32 offen offset:64 nt
    buffer_load_dwordx4 v[140:143], v14, s[12:15], s32 offen offset:128 nt
    buffer_load_dwordx4 v[144:147], v14, s[12:15], s32 offen offset:192 nt
    s_add_u32 s32, s32, 4096
    buffer_load_dwordx4 v[148:151], v14, s[12:15], s32 offen offset:0 nt
    buffer_load_dwordx4 v[152:155], v14, s[12:15], s32 offen offset:64 nt
    buffer_load_dwordx4 v[156:159], v14, s[12:15], s32 offen offset:128 nt
    buffer_load_dwordx4 v[160:163], v14, s[12:15], s32 offen offset:192 nt
    s_add_u32 s32, s32, 4096
    buffer_load_dwordx4 v[164:167], v14, s[12:15], s32 offen offset:0 nt
    buffer_load_dwordx4 v[168:171], v14, s[12:15], s32 offen offset:64 nt
    buffer_load_dwordx4 v[172:175], v14, s[12:15], s32 offen offset:128 nt
    buffer_load_dwordx4 v[176:179], v14, s[12:15], s32 offen offset:192 nt
    s_add_u32 s32, s32, 4096
    buffer_load_dwordx4 v[180:183], v14, s[12:15], s32 offen offset:0 nt
    buffer_load_dwordx4 v[184:187], v14, s[12:15], s32 offen offset:64 nt
    buffer_load_dwordx4 v[188:191], v14, s[12:15], s32 offen offset:128 nt
    buffer_load_dwordx4 v[192:195], v14, s[12:15], s32 offen offset:192 nt
    s_add_u32 s32, s32, 4096
    s_waitcnt vmcnt(24)
    v_add_f32 v4, v4, v6
    v_add_f32 v5, v5, v7
    v_add_f32 v8, v8, v10
    v_add_f32 v9, v9, v11
    v_add_f32 v4, v4, v8
    v_add_f32 v5, v5, v9
    v_cvt_pk_bf16_f32 v4, v4, v5
    v_lshlrev_b32 v5, 2, v0
    ds_write_b32 v5, v4
    v_mov_b32 v16, 0
    v_mov_b32 v17, 0
    v_mov_b32 v18, 0
    v_mov_b32 v19, 0
    v_mov_b32 v20, 0
    v_mov_b32 v21, 0
    v_mov_b32 v22, 0
    v_mov_b32 v23, 0
    v_mov_b32 v24, 0
    v_mov_b32 v25, 0
    v_mov_b32 v26, 0
    v_mov_b32 v27, 0
    v_mov_b32 v28, 0
    v_mov_b32 v29, 0
    v_mov_b32 v30, 0
    v_mov_b32 v31, 0
    v_lshlrev_b32 v5, 8, v12
    v_lshl_add_u32 v5, v13, 4, v5
    s_waitcnt lgkmcnt(0)
    s_barrier
    v_cmp_gt_u32 vcc, 4, v12
    s_and_saveexec_b64 s[36:37], vcc
    ds_read_b128 v[16:19], v5 offset:0
    ds_read_b128 v[20:23], v5 offset:64
    ds_read_b128 v[24:27], v5 offset:128
    ds_read_b128 v[28:31], v5 offset:192
    s_mov_b64 exec, s[36:37]
    s_waitcnt lgkmcnt(0)
    s_waitcnt vmcnt(20)
    v_mfma_f32_16x16x32_bf16 v[32:35], v[100:103], v[16:19], 0
    v_mfma_f32_16x16x32_bf16 v[32:35], v[104:107], v[20:23], v[32:35]
    v_mfma_f32_16x16x32_bf16 v[32:35], v[108:111], v[24:27], v[32:35]
    v_mfma_f32_16x16x32_bf16 v[32:35], v[112:115], v[28:31], v[32:35]
    buffer_load_dwordx4 v[100:103], v14, s[12:15], s32 offen offset:0 nt
    buffer_load_dwordx4 v[104:107], v14, s[12:15], s32 offen offset:64 nt
    buffer_load_dwordx4 v[108:111], v14, s[12:15], s32 offen offset:128 nt
    buffer_load_dwordx4 v[112:115], v14, s[12:15], s32 offen offset:192 nt
    s_add_u32 s32, s32, 4096
    s_waitcnt vmcnt(20)
    v_mfma_f32_16x16x32_bf16 v[36:39], v[116:119], v[16:19], 0
    v_mfma_f32_16x16x32_bf16 v[36:39], v[120:123], v[20:23], v[36:39]
    v_mfma_f32_16x16x32_bf16 v[36:39], v[124:127], v[24:27], v[36:39]
    v_mfma_f32_16x16x32_bf16 v[36:39], v[128:131], v[28:31], v[36:39]
    buffer_load_dwordx4 v[116:119], v14, s[12:15], s32 offen offset:0 nt
    buffer_load_dwordx4 v[120:123], v14, s[12:15], s32 offen offset:64 nt
    buffer_load_dwordx4 v[124:127], v14, s[12:15], s32 offen offset:128 nt
    buffer_load_dwordx4 v[128:131], v14, s[12:15], s32 offen offset:192 nt
    s_add_u32 s32, s32, 4096
    s_waitcnt vmcnt(20)
    v_mfma_f32_16x16x32_bf16 v[40:43], v[132:135], v[16:19], 0
    v_mfma_f32_16x16x32_bf16 v[40:43], v[136:139], v[20:23], v[40:43]
    v_mfma_f32_16x16x32_bf16 v[40:43], v[140:143], v[24:27], v[40:43]
    v_mfma_f32_16x16x32_bf16 v[40:43], v[144:147], v[28:31], v[40:43]
    buffer_load_dwordx4 v[132:135], v15, s[16:19], s33 offen offset:0 nt
    buffer_load_dwordx4 v[136:139], v15, s[16:19], s33 offen offset:256 nt
    buffer_load_dwordx4 v[140:143], v15, s[16:19], s33 offen offset:512 nt
    buffer_load_dwordx4 v[144:147], v15, s[16:19], s33 offen offset:768 nt
    s_waitcnt vmcnt(20)
    v_mfma_f32_16x16x32_bf16 v[44:47], v[148:151], v[16:19], 0
    v_mfma_f32_16x16x32_bf16 v[44:47], v[152:155], v[20:23], v[44:47]
    v_mfma_f32_16x16x32_bf16 v[44:47], v[156:159], v[24:27], v[44:47]
    v_mfma_f32_16x16x32_bf16 v[44:47], v[160:163], v[28:31], v[44:47]
    buffer_load_dwordx4 v[148:151], v15, s[16:19], s34 offen offset:0 nt
    buffer_load_dwordx4 v[152:155], v15, s[16:19], s34 offen offset:256 nt
    buffer_load_dwordx4 v[156:159], v15, s[16:19], s34 offen offset:512 nt
    buffer_load_dwordx4 v[160:163], v15, s[16:19], s34 offen offset:768 nt
    s_add_u32 s33, s33, 8192
    s_add_u32 s34, s34, 8192
    s_waitcnt vmcnt(20)
    v_mfma_f32_16x16x32_bf16 v[48:51], v[164:167], v[16:19], 0
    v_mfma_f32_16x16x32_bf16 v[48:51], v[168:171], v[20:23], v[48:51]
    v_mfma_f32_16x16x32_bf16 v[48:51], v[172:175], v[24:27], v[48:51]
    v_mfma_f32_16x16x32_bf16 v[48:51], v[176:179], v[28:31], v[48:51]
    buffer_load_dwordx4 v[164:167], v15, s[16:19], s33 offen offset:0 nt
    buffer_load_dwordx4 v[168:171], v15, s[16:19], s33 offen offset:256 nt
    buffer_load_dwordx4 v[172:175], v15, s[16:19], s33 offen offset:512 nt
    buffer_load_dwordx4 v[176:179], v15, s[16:19], s33 offen offset:768 nt
    s_waitcnt vmcnt(20)
    v_mfma_f32_16x16x32_bf16 v[52:55], v[180:183], v[16:19], 0
    v_mfma_f32_16x16x32_bf16 v[52:55], v[184:187], v[20:23], v[52:55]
    v_mfma_f32_16x16x32_bf16 v[52:55], v[188:191], v[24:27], v[52:55]
    v_mfma_f32_16x16x32_bf16 v[52:55], v[192:195], v[28:31], v[52:55]
    buffer_load_dwordx4 v[180:183], v15, s[16:19], s34 offen offset:0 nt
    buffer_load_dwordx4 v[184:187], v15, s[16:19], s34 offen offset:256 nt
    buffer_load_dwordx4 v[188:191], v15, s[16:19], s34 offen offset:512 nt
    buffer_load_dwordx4 v[192:195], v15, s[16:19], s34 offen offset:768 nt
    s_add_u32 s33, s33, 8192
    s_add_u32 s34, s34, 8192
    s_waitcnt vmcnt(20)
    v_mfma_f32_16x16x32_bf16 v[56:59], v[100:103], v[16:19], 0
    v_mfma_f32_16x16x32_bf16 v[56:59], v[104:107], v[20:23], v[56:59]
    v_mfma_f32_16x16x32_bf16 v[56:59], v[108:111], v[24:27], v[56:59]
    v_mfma_f32_16x16x32_bf16 v[56:59], v[112:115], v[28:31], v[56:59]
    buffer_load_dwordx4 v[100:103], v15, s[16:19], s33 offen offset:0 nt
    buffer_load_dwordx4 v[104:107], v15, s[16:19], s33 offen offset:256 nt
    buffer_load_dwordx4 v[108:111], v15, s[16:19], s33 offen offset:512 nt
    buffer_load_dwordx4 v[112:115], v15, s[16:19], s33 offen offset:768 nt
    s_waitcnt vmcnt(20)
    v_mfma_f32_16x16x32_bf16 v[60:63], v[116:119], v[16:19], 0
    v_mfma_f32_16x16x32_bf16 v[60:63], v[120:123], v[20:23], v[60:63]
    v_mfma_f32_16x16x32_bf16 v[60:63], v[124:127], v[24:27], v[60:63]
    v_mfma_f32_16x16x32_bf16 v[60:63], v[128:131], v[28:31], v[60:63]
    buffer_load_dwordx4 v[116:119], v15, s[16:19], s34 offen offset:0 nt
    buffer_load_dwordx4 v[120:123], v15, s[16:19], s34 offen offset:256 nt
    buffer_load_dwordx4 v[124:127], v15, s[16:19], s34 offen offset:512 nt
    buffer_load_dwordx4 v[128:131], v15, s[16:19], s34 offen offset:768 nt
    s_add_u32 s33, s33, 8192
    s_add_u32 s34, s34, 8192
    s_nop 7
    s_nop 1
    s_mov_b32 s38, 0x3db504f3
    v_cvt_pk_bf16_f32 v4, v32, v33
    v_lshlrev_b32 v32, 16, v4
    v_and_b32 v33, 0xffff0000, v4
    v_mul_f32 v32, s38, v32
    v_mul_f32 v33, s38, v33
    v_cvt_pk_bf16_f32 v4, v32, v33
    v_lshlrev_b32 v32, 16, v4
    v_and_b32 v33, 0xffff0000, v4
    v_cvt_pk_bf16_f32 v4, v34, v35
    v_lshlrev_b32 v34, 16, v4
    v_and_b32 v35, 0xffff0000, v4
    v_mul_f32 v34, s38, v34
    v_mul_f32 v35, s38, v35
    v_cvt_pk_bf16_f32 v4, v34, v35
    v_lshlrev_b32 v34, 16, v4
    v_and_b32 v35, 0xffff0000, v4
    v_cvt_pk_bf16_f32 v4, v36, v37
    v_lshlrev_b32 v36, 16, v4
    v_and_b32 v37, 0xffff0000, v4
    v_mul_f32 v36, s38, v36
    v_mul_f32 v37, s38, v37
    v_cvt_pk_bf16_f32 v4, v36, v37
    v_lshlrev_b32 v36, 16, v4
    v_and_b32 v37, 0xffff0000, v4
    v_cvt_pk_bf16_f32 v4, v38, v39
    v_lshlrev_b32 v38, 16, v4
    v_and_b32 v39, 0xffff0000, v4
    v_mul_f32 v38, s38, v38
    v_mul_f32 v39, s38, v39
    v_cvt_pk_bf16_f32 v4, v38, v39
    v_lshlrev_b32 v38, 16, v4
    v_and_b32 v39, 0xffff0000, v4
    v_cvt_pk_bf16_f32 v4, v40, v41
    v_lshlrev_b32 v40, 16, v4
    v_and_b32 v41, 0xffff0000, v4
    v_mul_f32 v40, s38, v40
    v_mul_f32 v41, s38, v41
    v_cvt_pk_bf16_f32 v4, v40, v41
    v_lshlrev_b32 v40, 16, v4
    v_and_b32 v41, 0xffff0000, v4
    v_cvt_pk_bf16_f32 v4, v42, v43
    v_lshlrev_b32 v42, 16, v4
    v_and_b32 v43, 0xffff0000, v4
    v_mul_f32 v42, s38, v42
    v_mul_f32 v43, s38, v43
    v_cvt_pk_bf16_f32 v4, v42, v43
    v_lshlrev_b32 v42, 16, v4
    v_and_b32 v43, 0xffff0000, v4
    v_cvt_pk_bf16_f32 v4, v44, v45
    v_lshlrev_b32 v44, 16, v4
    v_and_b32 v45, 0xffff0000, v4
    v_mul_f32 v44, s38, v44
    v_mul_f32 v45, s38, v45
    v_cvt_pk_bf16_f32 v4, v44, v45
    v_lshlrev_b32 v44, 16, v4
    v_and_b32 v45, 0xffff0000, v4
    v_cvt_pk_bf16_f32 v4, v46, v47
    v_lshlrev_b32 v46, 16, v4
    v_and_b32 v47, 0xffff0000, v4
    v_mul_f32 v46, s38, v46
    v_mul_f32 v47, s38, v47
    v_cvt_pk_bf16_f32 v4, v46, v47
    v_lshlrev_b32 v46, 16, v4
    v_and_b32 v47, 0xffff0000, v4
    v_cvt_pk_bf16_f32 v4, v48, v49
    v_lshlrev_b32 v48, 16, v4
    v_and_b32 v49, 0xffff0000, v4
    v_mul_f32 v48, s38, v48
    v_mul_f32 v49, s38, v49
    v_cvt_pk_bf16_f32 v4, v48, v49
    v_lshlrev_b32 v48, 16, v4
    v_and_b32 v49, 0xffff0000, v4
    v_cvt_pk_bf16_f32 v4, v50, v51
    v_lshlrev_b32 v50, 16, v4
    v_and_b32 v51, 0xffff0000, v4
    v_mul_f32 v50, s38, v50
    v_mul_f32 v51, s38, v51
    v_cvt_pk_bf16_f32 v4, v50, v51
    v_lshlrev_b32 v50, 16, v4
    v_and_b32 v51, 0xffff0000, v4
    v_cvt_pk_bf16_f32 v4, v52, v53
    v_lshlrev_b32 v52, 16, v4
    v_and_b32 v53, 0xffff0000, v4
    v_mul_f32 v52, s38, v52
    v_mul_f32 v53, s38, v53
    v_cvt_pk_bf16_f32 v4, v52, v53
    v_lshlrev_b32 v52, 16, v4
    v_and_b32 v53, 0xffff0000, v4
    v_cvt_pk_bf16_f32 v4, v54, v55
    v_lshlrev_b32 v54, 16, v4
    v_and_b32 v55, 0xffff0000, v4
    v_mul_f32 v54, s38, v54
    v_mul_f32 v55, s38, v55
    v_cvt_pk_bf16_f32 v4, v54, v55
    v_lshlrev_b32 v54, 16, v4
    v_and_b32 v55, 0xffff0000, v4
    v_cvt_pk_bf16_f32 v4, v56, v57
    v_lshlrev_b32 v56, 16, v4
    v_and_b32 v57, 0xffff0000, v4
    v_mul_f32 v56, s38, v56
    v_mul_f32 v57, s38, v57
    v_cvt_pk_bf16_f32 v4, v56, v57
    v_lshlrev_b32 v56, 16, v4
    v_and_b32 v57, 0xffff0000, v4
    v_cvt_pk_bf16_f32 v4, v58, v59
    v_lshlrev_b32 v58, 16, v4
    v_and_b32 v59, 0xffff0000, v4
    v_mul_f32 v58, s38, v58
    v_mul_f32 v59, s38, v59
    v_cvt_pk_bf16_f32 v4, v58, v59
    v_lshlrev_b32 v58, 16, v4
    v_and_b32 v59, 0xffff0000, v4
    v_cvt_pk_bf16_f32 v4, v60, v61
    v_lshlrev_b32 v60, 16, v4
    v_and_b32 v61, 0xffff0000, v4
    v_mul_f32 v60, s38, v60
    v_mul_f32 v61, s38, v61
    v_cvt_pk_bf16_f32 v4, v60, v61
    v_lshlrev_b32 v60, 16, v4
    v_and_b32 v61, 0xffff0000, v4
    v_cvt_pk_bf16_f32 v4, v62, v63
    v_lshlrev_b32 v62, 16, v4
    v_and_b32 v63, 0xffff0000, v4
    v_mul_f32 v62, s38, v62
    v_mul_f32 v63, s38, v63
    v_cvt_pk_bf16_f32 v4, v62, v63
    v_lshlrev_b32 v62, 16, v4
    v_and_b32 v63, 0xffff0000, v4
    v_max_f32 v4, v32, v33
    v_max3_f32 v4, v4, v34, v35
    v_max3_f32 v4, v4, v36, v37
    v_max3_f32 v4, v4, v38, v39
    v_max3_f32 v4, v4, v40, v41
    v_max3_f32 v4, v4, v42, v43
    v_max3_f32 v4, v4, v44, v45
    v_max3_f32 v4, v4, v46, v47
    v_max3_f32 v4, v4, v48, v49
    v_max3_f32 v4, v4, v50, v51
    v_max3_f32 v4, v4, v52, v53
    v_max3_f32 v4, v4, v54, v55
    v_max3_f32 v4, v4, v56, v57
    v_max3_f32 v4, v4, v58, v59
    v_max3_f32 v4, v4, v60, v61
    v_max3_f32 v4, v4, v62, v63
    v_xor_b32 v5, 16, v2
    v_lshlrev_b32 v5, 2, v5
    v_xor_b32 v6, 32, v2
    v_lshlrev_b32 v6, 2, v6
    ds_bpermute_b32 v7, v5, v4
    s_waitcnt lgkmcnt(0)
    v_max_f32 v4, v4, v7
    ds_bpermute_b32 v7, v6, v4
    s_waitcnt lgkmcnt(0)
    v_max_f32 v4, v4, v7
    v_mov_b32 v8, 0
    v_sub_f32 v32, v32, v4
    v_mul_f32 v32, 0x3fb8aa3b, v32
    v_exp_f32 v32, v32
    s_nop 0
    v_add_f32 v8, v8, v32
    v_sub_f32 v33, v33, v4
    v_mul_f32 v33, 0x3fb8aa3b, v33
    v_exp_f32 v33, v33
    s_nop 0
    v_add_f32 v8, v8, v33
    v_sub_f32 v34, v34, v4
    v_mul_f32 v34, 0x3fb8aa3b, v34
    v_exp_f32 v34, v34
    s_nop 0
    v_add_f32 v8, v8, v34
    v_sub_f32 v35, v35, v4
    v_mul_f32 v35, 0x3fb8aa3b, v35
    v_exp_f32 v35, v35
    s_nop 0
    v_add_f32 v8, v8, v35
    v_sub_f32 v36, v36, v4
    v_mul_f32 v36, 0x3fb8aa3b, v36
    v_exp_f32 v36, v36
    s_nop 0
    v_add_f32 v8, v8, v36
    v_sub_f32 v37, v37, v4
    v_mul_f32 v37, 0x3fb8aa3b, v37
    v_exp_f32 v37, v37
    s_nop 0
    v_add_f32 v8, v8, v37
    v_sub_f32 v38, v38, v4
    v_mul_f32 v38, 0x3fb8aa3b, v38
    v_exp_f32 v38, v38
    s_nop 0
    v_add_f32 v8, v8, v38
    v_sub_f32 v39, v39, v4
    v_mul_f32 v39, 0x3fb8aa3b, v39
    v_exp_f32 v39, v39
    s_nop 0
    v_add_f32 v8, v8, v39
    v_sub_f32 v40, v40, v4
    v_mul_f32 v40, 0x3fb8aa3b, v40
    v_exp_f32 v40, v40
    s_nop 0
    v_add_f32 v8, v8, v40
    v_sub_f32 v41, v41, v4
    v_mul_f32 v41, 0x3fb8aa3b, v41
    v_exp_f32 v41, v41
    s_nop 0
    v_add_f32 v8, v8, v41
    v_sub_f32 v42, v42, v4
    v_mul_f32 v42, 0x3fb8aa3b, v42
    v_exp_f32 v42, v42
    s_nop 0
    v_add_f32 v8, v8, v42
    v_sub_f32 v43, v43, v4
    v_mul_f32 v43, 0x3fb8aa3b, v43
    v_exp_f32 v43, v43
    s_nop 0
    v_add_f32 v8, v8, v43
    v_sub_f32 v44, v44, v4
    v_mul_f32 v44, 0x3fb8aa3b, v44
    v_exp_f32 v44, v44
    s_nop 0
    v_add_f32 v8, v8, v44
    v_sub_f32 v45, v45, v4
    v_mul_f32 v45, 0x3fb8aa3b, v45
    v_exp_f32 v45, v45
    s_nop 0
    v_add_f32 v8, v8, v45
    v_sub_f32 v46, v46, v4
    v_mul_f32 v46, 0x3fb8aa3b, v46
    v_exp_f32 v46, v46
    s_nop 0
    v_add_f32 v8, v8, v46
    v_sub_f32 v47, v47, v4
    v_mul_f32 v47, 0x3fb8aa3b, v47
    v_exp_f32 v47, v47
    s_nop 0
    v_add_f32 v8, v8, v47
    v_sub_f32 v48, v48, v4
    v_mul_f32 v48, 0x3fb8aa3b, v48
    v_exp_f32 v48, v48
    s_nop 0
    v_add_f32 v8, v8, v48
    v_sub_f32 v49, v49, v4
    v_mul_f32 v49, 0x3fb8aa3b, v49
    v_exp_f32 v49, v49
    s_nop 0
    v_add_f32 v8, v8, v49
    v_sub_f32 v50, v50, v4
    v_mul_f32 v50, 0x3fb8aa3b, v50
    v_exp_f32 v50, v50
    s_nop 0
    v_add_f32 v8, v8, v50
    v_sub_f32 v51, v51, v4
    v_mul_f32 v51, 0x3fb8aa3b, v51
    v_exp_f32 v51, v51
    s_nop 0
    v_add_f32 v8, v8, v51
    v_sub_f32 v52, v52, v4
    v_mul_f32 v52, 0x3fb8aa3b, v52
    v_exp_f32 v52, v52
    s_nop 0
    v_add_f32 v8, v8, v52
    v_sub_f32 v53, v53, v4
    v_mul_f32 v53, 0x3fb8aa3b, v53
    v_exp_f32 v53, v53
    s_nop 0
    v_add_f32 v8, v8, v53
    v_sub_f32 v54, v54, v4
    v_mul_f32 v54, 0x3fb8aa3b, v54
    v_exp_f32 v54, v54
    s_nop 0
    v_add_f32 v8, v8, v54
    v_sub_f32 v55, v55, v4
    v_mul_f32 v55, 0x3fb8aa3b, v55
    v_exp_f32 v55, v55
    s_nop 0
    v_add_f32 v8, v8, v55
    v_sub_f32 v56, v56, v4
    v_mul_f32 v56, 0x3fb8aa3b, v56
    v_exp_f32 v56, v56
    s_nop 0
    v_add_f32 v8, v8, v56
    v_sub_f32 v57, v57, v4
    v_mul_f32 v57, 0x3fb8aa3b, v57
    v_exp_f32 v57, v57
    s_nop 0
    v_add_f32 v8, v8, v57
    v_sub_f32 v58, v58, v4
    v_mul_f32 v58, 0x3fb8aa3b, v58
    v_exp_f32 v58, v58
    s_nop 0
    v_add_f32 v8, v8, v58
    v_sub_f32 v59, v59, v4
    v_mul_f32 v59, 0x3fb8aa3b, v59
    v_exp_f32 v59, v59
    s_nop 0
    v_add_f32 v8, v8, v59
    v_sub_f32 v60, v60, v4
    v_mul_f32 v60, 0x3fb8aa3b, v60
    v_exp_f32 v60, v60
    s_nop 0
    v_add_f32 v8, v8, v60
    v_sub_f32 v61, v61, v4
    v_mul_f32 v61, 0x3fb8aa3b, v61
    v_exp_f32 v61, v61
    s_nop 0
    v_add_f32 v8, v8, v61
    v_sub_f32 v62, v62, v4
    v_mul_f32 v62, 0x3fb8aa3b, v62
    v_exp_f32 v62, v62
    s_nop 0
    v_add_f32 v8, v8, v62
    v_sub_f32 v63, v63, v4
    v_mul_f32 v63, 0x3fb8aa3b, v63
    v_exp_f32 v63, v63
    s_nop 0
    v_add_f32 v8, v8, v63
    v_cvt_pk_bf16_f32 v232, v32, v33
    v_cvt_pk_bf16_f32 v233, v34, v35
    v_cvt_pk_bf16_f32 v234, v36, v37
    v_cvt_pk_bf16_f32 v235, v38, v39
    v_cvt_pk_bf16_f32 v236, v40, v41
    v_cvt_pk_bf16_f32 v237, v42, v43
    v_cvt_pk_bf16_f32 v238, v44, v45
    v_cvt_pk_bf16_f32 v239, v46, v47
    v_cvt_pk_bf16_f32 v240, v48, v49
    v_cvt_pk_bf16_f32 v241, v50, v51
    v_cvt_pk_bf16_f32 v242, v52, v53
    v_cvt_pk_bf16_f32 v243, v54, v55
    v_cvt_pk_bf16_f32 v244, v56, v57
    v_cvt_pk_bf16_f32 v245, v58, v59
    v_cvt_pk_bf16_f32 v246, v60, v61
    v_cvt_pk_bf16_f32 v247, v62, v63
    ds_bpermute_b32 v7, v5, v8
    s_waitcnt lgkmcnt(0)
    v_add_f32 v8, v8, v7
    ds_bpermute_b32 v7, v6, v8
    s_waitcnt lgkmcnt(0)
    v_add_f32 v8, v8, v7
    s_mov_b32 s40, 0x05040100
    s_mov_b32 s41, 0x07060302
    s_waitcnt vmcnt(16)
    v_perm_b32 v64, v136, v132, s40
    v_perm_b32 v65, v144, v140, s40
    v_perm_b32 v66, v152, v148, s40
    v_perm_b32 v67, v160, v156, s40
    v_perm_b32 v68, v136, v132, s41
    v_perm_b32 v69, v144, v140, s41
    v_perm_b32 v70, v152, v148, s41
    v_perm_b32 v71, v160, v156, s41
    v_perm_b32 v72, v137, v133, s40
    v_perm_b32 v73, v145, v141, s40
    v_perm_b32 v74, v153, v149, s40
    v_perm_b32 v75, v161, v157, s40
    v_perm_b32 v76, v137, v133, s41
    v_perm_b32 v77, v145, v141, s41
    v_perm_b32 v78, v153, v149, s41
    v_perm_b32 v79, v161, v157, s41
    v_perm_b32 v80, v138, v134, s40
    v_perm_b32 v81, v146, v142, s40
    v_perm_b32 v82, v154, v150, s40
    v_perm_b32 v83, v162, v158, s40
    v_perm_b32 v84, v138, v134, s41
    v_perm_b32 v85, v146, v142, s41
    v_perm_b32 v86, v154, v150, s41
    v_perm_b32 v87, v162, v158, s41
    v_perm_b32 v88, v139, v135, s40
    v_perm_b32 v89, v147, v143, s40
    v_perm_b32 v90, v155, v151, s40
    v_perm_b32 v91, v163, v159, s40
    v_perm_b32 v92, v139, v135, s41
    v_perm_b32 v93, v147, v143, s41
    v_perm_b32 v94, v155, v151, s41
    v_perm_b32 v95, v163, v159, s41
    buffer_load_dwordx4 v[132:135], v15, s[16:19], s33 offen offset:0 nt
    buffer_load_dwordx4 v[136:139], v15, s[16:19], s33 offen offset:256 nt
    buffer_load_dwordx4 v[140:143], v15, s[16:19], s33 offen offset:512 nt
    buffer_load_dwordx4 v[144:147], v15, s[16:19], s33 offen offset:768 nt
    buffer_load_dwordx4 v[148:151], v15, s[16:19], s34 offen offset:0 nt
    buffer_load_dwordx4 v[152:155], v15, s[16:19], s34 offen offset:256 nt
    buffer_load_dwordx4 v[156:159], v15, s[16:19], s34 offen offset:512 nt
    buffer_load_dwordx4 v[160:163], v15, s[16:19], s34 offen offset:768 nt
    s_add_u32 s33, s33, 8192
    s_add_u32 s34, s34, 8192
    s_nop 1
    v_mfma_f32_16x16x32_bf16 v[200:203], v[232:235], v[64:67], 0
    v_mfma_f32_16x16x32_bf16 v[204:207], v[232:235], v[68:71], 0
    v_mfma_f32_16x16x32_bf16 v[208:211], v[232:235], v[72:75], 0
    v_mfma_f32_16x16x32_bf16 v[212:215], v[232:235], v[76:79], 0
    v_mfma_f32_16x16x32_bf16 v[216:219], v[232:235], v[80:83], 0
    v_mfma_f32_16x16x32_bf16 v[220:223], v[232:235], v[84:87], 0
    v_mfma_f32_16x16x32_bf16 v[224:227], v[232:235], v[88:91], 0
    v_mfma_f32_16x16x32_bf16 v[228:231], v[232:235], v[92:95], 0
    s_nop 3
    s_waitcnt vmcnt(16)
    v_perm_b32 v64, v168, v164, s40
    v_perm_b32 v65, v176, v172, s40
    v_perm_b32 v66, v184, v180, s40
    v_perm_b32 v67, v192, v188, s40
    v_perm_b32 v68, v168, v164, s41
    v_perm_b32 v69, v176, v172, s41
    v_perm_b32 v70, v184, v180, s41
    v_perm_b32 v71, v192, v188, s41
    v_perm_b32 v72, v169, v165, s40
    v_perm_b32 v73, v177, v173, s40
    v_perm_b32 v74, v185, v181, s40
    v_perm_b32 v75, v193, v189, s40
    v_perm_b32 v76, v169, v165, s41
    v_perm_b32 v77, v177, v173, s41
    v_perm_b32 v78, v185, v181, s41
    v_perm_b32 v79, v193, v189, s41
    v_perm_b32 v80, v170, v166, s40
    v_perm_b32 v81, v178, v174, s40
    v_perm_b32 v82, v186, v182, s40
    v_perm_b32 v83, v194, v190, s40
    v_perm_b32 v84, v170, v166, s41
    v_perm_b32 v85, v178, v174, s41
    v_perm_b32 v86, v186, v182, s41
    v_perm_b32 v87, v194, v190, s41
    v_perm_b32 v88, v171, v167, s40
    v_perm_b32 v89, v179, v175, s40
    v_perm_b32 v90, v187, v183, s40
    v_perm_b32 v91, v195, v191, s40
    v_perm_b32 v92, v171, v167, s41
    v_perm_b32 v93, v179, v175, s41
    v_perm_b32 v94, v187, v183, s41
    v_perm_b32 v95, v195, v191, s41
    s_nop 1
    v_mfma_f32_16x16x32_bf16 v[200:203], v[236:239], v[64:67], v[200:203]
    v_mfma_f32_16x16x32_bf16 v[204:207], v[236:239], v[68:71], v[204:207]
    v_mfma_f32_16x16x32_bf16 v[208:211], v[236:239], v[72:75], v[208:211]
    v_mfma_f32_16x16x32_bf16 v[212:215], v[236:239], v[76:79], v[212:215]
    v_mfma_f32_16x16x32_bf16 v[216:219], v[236:239], v[80:83], v[216:219]
    v_mfma_f32_16x16x32_bf16 v[220:223], v[236:239], v[84:87], v[220:223]
    v_mfma_f32_16x16x32_bf16 v[224:227], v[236:239], v[88:91], v[224:227]
    v_mfma_f32_16x16x32_bf16 v[228:231], v[236:239], v[92:95], v[228:231]
    s_nop 3
    s_waitcnt vmcnt(8)
    v_perm_b32 v64, v104, v100, s40
    v_perm_b32 v65, v112, v108, s40
    v_perm_b32 v66, v120, v116, s40
    v_perm_b32 v67, v128, v124, s40
    v_perm_b32 v68, v104, v100, s41
    v_perm_b32 v69, v112, v108, s41
    v_perm_b32 v70, v120, v116, s41
    v_perm_b32 v71, v128, v124, s41
    v_perm_b32 v72, v105, v101, s40
    v_perm_b32 v73, v113, v109, s40
    v_perm_b32 v74, v121, v117, s40
    v_perm_b32 v75, v129, v125, s40
    v_perm_b32 v76, v105, v101, s41
    v_perm_b32 v77, v113, v109, s41
    v_perm_b32 v78, v121, v117, s41
    v_perm_b32 v79, v129, v125, s41
    v_perm_b32 v80, v106, v102, s40
    v_perm_b32 v81, v114, v110, s40
    v_perm_b32 v82, v122, v118, s40
    v_perm_b32 v83, v130, v126, s40
    v_perm_b32 v84, v106, v102, s41
    v_perm_b32 v85, v114, v110, s41
    v_perm_b32 v86, v122, v118, s41
    v_perm_b32 v87, v130, v126, s41
    v_perm_b32 v88, v107, v103, s40
    v_perm_b32 v89, v115, v111, s40
    v_perm_b32 v90, v123, v119, s40
    v_perm_b32 v91, v131, v127, s40
    v_perm_b32 v92, v107, v103, s41
    v_perm_b32 v93, v115, v111, s41
    v_perm_b32 v94, v123, v119, s41
    v_perm_b32 v95, v131, v127, s41
    s_nop 1
    v_mfma_f32_16x16x32_bf16 v[200:203], v[240:243], v[64:67], v[200:203]
    v_mfma_f32_16x16x32_bf16 v[204:207], v[240:243], v[68:71], v[204:207]
    v_mfma_f32_16x16x32_bf16 v[208:211], v[240:243], v[72:75], v[208:211]
    v_mfma_f32_16x16x32_bf16 v[212:215], v[240:243], v[76:79], v[212:215]
    v_mfma_f32_16x16x32_bf16 v[216:219], v[240:243], v[80:83], v[216:219]
    v_mfma_f32_16x16x32_bf16 v[220:223], v[240:243], v[84:87], v[220:223]
    v_mfma_f32_16x16x32_bf16 v[224:227], v[240:243], v[88:91], v[224:227]
    v_mfma_f32_16x16x32_bf16 v[228:231], v[240:243], v[92:95], v[228:231]
    s_nop 3
    s_waitcnt vmcnt(0)
    v_perm_b32 v64, v136, v132, s40
    v_perm_b32 v65, v144, v140, s40
    v_perm_b32 v66, v152, v148, s40
    v_perm_b32 v67, v160, v156, s40
    v_perm_b32 v68, v136, v132, s41
    v_perm_b32 v69, v144, v140, s41
    v_perm_b32 v70, v152, v148, s41
    v_perm_b32 v71, v160, v156, s41
    v_perm_b32 v72, v137, v133, s40
    v_perm_b32 v73, v145, v141, s40
    v_perm_b32 v74, v153, v149, s40
    v_perm_b32 v75, v161, v157, s40
    v_perm_b32 v76, v137, v133, s41
    v_perm_b32 v77, v145, v141, s41
    v_perm_b32 v78, v153, v149, s41
    v_perm_b32 v79, v161, v157, s41
    v_perm_b32 v80, v138, v134, s40
    v_perm_b32 v81, v146, v142, s40
    v_perm_b32 v82, v154, v150, s40
    v_perm_b32 v83, v162, v158, s40
    v_perm_b32 v84, v138, v134, s41
    v_perm_b32 v85, v146, v142, s41
    v_perm_b32 v86, v154, v150, s41
    v_perm_b32 v87, v162, v158, s41
    v_perm_b32 v88, v139, v135, s40
    v_perm_b32 v89, v147, v143, s40
    v_perm_b32 v90, v155, v151, s40
    v_perm_b32 v91, v163, v159, s40
    v_perm_b32 v92, v139, v135, s41
    v_perm_b32 v93, v147, v143, s41
    v_perm_b32 v94, v155, v151, s41
    v_perm_b32 v95, v163, v159, s41
    s_nop 1
    v_mfma_f32_16x16x32_bf16 v[200:203], v[244:247], v[64:67], v[200:203]
    v_mfma_f32_16x16x32_bf16 v[204:207], v[244:247], v[68:71], v[204:207]
    v_mfma_f32_16x16x32_bf16 v[208:211], v[244:247], v[72:75], v[208:211]
    v_mfma_f32_16x16x32_bf16 v[212:215], v[244:247], v[76:79], v[212:215]
    v_mfma_f32_16x16x32_bf16 v[216:219], v[244:247], v[80:83], v[216:219]
    v_mfma_f32_16x16x32_bf16 v[220:223], v[244:247], v[84:87], v[220:223]
    v_mfma_f32_16x16x32_bf16 v[224:227], v[244:247], v[88:91], v[224:227]
    v_mfma_f32_16x16x32_bf16 v[228:231], v[244:247], v[92:95], v[228:231]
    s_nop 3
    s_nop 7
    s_nop 1
    s_lshl_b32 s42, s3, 11
    s_add_u32 s42, s42, 1024
    v_lshlrev_b32 v9, 5, v2
    v_add_u32 v9, s42, v9
    v_cmp_gt_u32 vcc, 16, v2
    s_and_saveexec_b64 s[36:37], vcc
    ds_write_b32 v9, v200 offset:0
    ds_write_b32 v9, v201 offset:512
    ds_write_b32 v9, v202 offset:1024
    ds_write_b32 v9, v203 offset:1536
    ds_write_b32 v9, v204 offset:4
    ds_write_b32 v9, v205 offset:516
    ds_write_b32 v9, v206 offset:1028
    ds_write_b32 v9, v207 offset:1540
    ds_write_b32 v9, v208 offset:8
    ds_write_b32 v9, v209 offset:520
    ds_write_b32 v9, v210 offset:1032
    ds_write_b32 v9, v211 offset:1544
    ds_write_b32 v9, v212 offset:12
    ds_write_b32 v9, v213 offset:524
    ds_write_b32 v9, v214 offset:1036
    ds_write_b32 v9, v215 offset:1548
    ds_write_b32 v9, v216 offset:16
    ds_write_b32 v9, v217 offset:528
    ds_write_b32 v9, v218 offset:1040
    ds_write_b32 v9, v219 offset:1552
    ds_write_b32 v9, v220 offset:20
    ds_write_b32 v9, v221 offset:532
    ds_write_b32 v9, v222 offset:1044
    ds_write_b32 v9, v223 offset:1556
    ds_write_b32 v9, v224 offset:24
    ds_write_b32 v9, v225 offset:536
    ds_write_b32 v9, v226 offset:1048
    ds_write_b32 v9, v227 offset:1560
    ds_write_b32 v9, v228 offset:28
    ds_write_b32 v9, v229 offset:540
    ds_write_b32 v9, v230 offset:1052
    ds_write_b32 v9, v231 offset:1564
    s_mov_b64 exec, s[36:37]
    s_lshl_b32 s42, s3, 4
    s_add_u32 s42, s42, 9216
    v_lshlrev_b32 v9, 2, v2
    v_add_u32 v9, s42, v9
    v_cmp_gt_u32 vcc, 4, v2
    s_and_saveexec_b64 s[36:37], vcc
    ds_write_b32 v9, v4
    ds_write_b32 v9, v8 offset:64
    s_mov_b64 exec, s[36:37]
    s_waitcnt lgkmcnt(0)
    s_barrier
    v_lshlrev_b32 v9, 2, v1
    ds_read_b32 v20, v9 offset:9216
    ds_read_b32 v24, v9 offset:9280
    ds_read_b32 v21, v9 offset:9232
    ds_read_b32 v25, v9 offset:9296
    ds_read_b32 v22, v9 offset:9248
    ds_read_b32 v26, v9 offset:9312
    ds_read_b32 v23, v9 offset:9264
    ds_read_b32 v27, v9 offset:9328
    v_lshlrev_b32 v10, 9, v1
    v_lshl_add_u32 v10, v2, 3, v10
    ds_read_b64 v[28:29], v10 offset:1024
    ds_read_b64 v[30:31], v10 offset:3072
    ds_read_b64 v[32:33], v10 offset:5120
    ds_read_b64 v[34:35], v10 offset:7168
    s_waitcnt lgkmcnt(0)
    v_max_f32 v4, v20, v21
    v_max3_f32 v4, v4, v22, v23
    v_mov_b32 v8, 0
    v_mov_b32 v16, 0
    v_mov_b32 v17, 0
    v_sub_f32 v11, v20, v4
    v_mul_f32 v11, 0x3fb8aa3b, v11
    v_exp_f32 v11, v11
    s_nop 0
    v_fmac_f32 v8, v11, v24
    v_fmac_f32 v16, v11, v28
    v_fmac_f32 v17, v11, v29
    v_sub_f32 v11, v21, v4
    v_mul_f32 v11, 0x3fb8aa3b, v11
    v_exp_f32 v11, v11
    s_nop 0
    v_fmac_f32 v8, v11, v25
    v_fmac_f32 v16, v11, v30
    v_fmac_f32 v17, v11, v31
    v_sub_f32 v11, v22, v4
    v_mul_f32 v11, 0x3fb8aa3b, v11
    v_exp_f32 v11, v11
    s_nop 0
    v_fmac_f32 v8, v11, v26
    v_fmac_f32 v16, v11, v32
    v_fmac_f32 v17, v11, v33
    v_sub_f32 v11, v23, v4
    v_mul_f32 v11, 0x3fb8aa3b, v11
    v_exp_f32 v11, v11
    s_nop 0
    v_fmac_f32 v8, v11, v27
    v_fmac_f32 v16, v11, v34
    v_fmac_f32 v17, v11, v35
    s_lshl_b32 s42, s2, 11
    s_add_u32 s42, s42, 0x100000
    buffer_store_dwordx2 v[16:17], v3, s[20:23], s42 offen
    v_mov_b32 v5, v8
    s_lshl_b32 s42, s2, 5
    s_add_u32 s42, s42, 0x200000
    v_lshlrev_b32 v9, 3, v1
    v_cmp_eq_u32 vcc, 0, v2
    s_and_saveexec_b64 s[36:37], vcc
    buffer_store_dwordx2 v[4:5], v9, s[20:23], s42 offen
    s_mov_b64 exec, s[36:37]
K2_done:
    s_endpgm
.globl recurrent_scan__gqa_block_cached__dense_activation_gelu__decode_k3_kernel
.p2align 8
.type recurrent_scan__gqa_block_cached__dense_activation_gelu__decode_k3_kernel,@function
recurrent_scan__gqa_block_cached__dense_activation_gelu__decode_k3_kernel:
    s_cmp_ge_u32 s2, 184
    s_cbranch_scc1 K3_done
    s_load_dwordx2 s[4:5], s[0:1], 32
    s_load_dwordx2 s[6:7], s[0:1], 64
    s_load_dwordx2 s[10:11], s[0:1], 56
    s_load_dwordx2 s[8:9], s[0:1], 96
    v_lshrrev_b32 v1, 6, v0
    v_and_b32 v2, 63, v0
    s_nop 0
    v_readfirstlane_b32 s3, v1
    s_waitcnt lgkmcnt(0)
    s_mov_b32 s20, s8
    s_mov_b32 s21, s9
    s_mov_b32 s22, 0x210000
    s_mov_b32 s23, 0x00020000
    s_cmp_ge_u32 s2, 128
    s_cbranch_scc1 K3_fsel
    s_mov_b32 s16, s4
    s_mov_b32 s17, s5
    s_mov_b32 s18, 0x400000
    s_mov_b32 s19, 0x00020000
    s_mov_b32 s25, s2
    s_mov_b32 s44, 0xc0000
    s_branch K3_sel_done
K3_fsel:
    s_mov_b32 s16, s6
    s_mov_b32 s17, s7
    s_mov_b32 s18, 0x1c0000
    s_mov_b32 s19, 0x00020000
    s_sub_u32 s25, s2, 128
    s_mov_b32 s44, 0xc4000
K3_sel_done:
    s_lshr_b32 s27, s25, 2
    s_and_b32 s28, s25, 3
    s_lshl_b32 s29, s27, 7
    s_lshl_b32 s30, s3, 5
    s_add_u32 s29, s29, s30
    s_lshl_b32 s30, s29, 10
    s_lshl_b32 s31, s28, 8
    s_add_u32 s30, s30, s31
    v_lshrrev_b32 v4, 4, v2
    v_lshlrev_b32 v4, 13, v4
    v_and_b32 v5, 15, v2
    v_lshlrev_b32 v5, 4, v5
    v_add_u32 v4, v4, v5
    buffer_load_dwordx4 v[32:35], v4, s[16:19], s30 offen
    s_add_u32 s30, s30, 1024
    buffer_load_dwordx4 v[36:39], v4, s[16:19], s30 offen
    s_add_u32 s30, s30, 1024
    buffer_load_dwordx4 v[40:43], v4, s[16:19], s30 offen
    s_add_u32 s30, s30, 1024
    buffer_load_dwordx4 v[44:47], v4, s[16:19], s30 offen
    s_add_u32 s30, s30, 1024
    buffer_load_dwordx4 v[48:51], v4, s[16:19], s30 offen
    s_add_u32 s30, s30, 1024
    buffer_load_dwordx4 v[52:55], v4, s[16:19], s30 offen
    s_add_u32 s30, s30, 1024
    buffer_load_dwordx4 v[56:59], v4, s[16:19], s30 offen
    s_add_u32 s30, s30, 1024
    buffer_load_dwordx4 v[60:63], v4, s[16:19], s30 offen
    v_lshrrev_b32 v6, 5, v0
    v_and_b32 v7, 31, v0
    s_cmp_ge_u32 s2, 128
    s_cbranch_scc1 K3_fpre
    s_lshr_b32 s31, s27, 2
    s_and_b32 s32, s27, 3
    s_lshl_b32 s33, s31, 14
    s_lshl_b32 s34, s32, 9
    s_add_u32 s33, s33, s34
    s_add_u32 s33, s33, 0x100000
    v_lshlrev_b32 v8, 17, v6
    v_lshl_add_u32 v8, v7, 4, v8
    buffer_load_dwordx4 v[96:99], v8, s[20:23], s33 offen offset:0
    buffer_load_dwordx4 v[100:103], v8, s[20:23], s33 offen offset:2048
    s_nop 0
    s_nop 0
    s_nop 0
    s_nop 0
    s_nop 0
    s_nop 0
    s_add_u32 s34, s33, 4096
    buffer_load_dwordx4 v[104:107], v8, s[20:23], s34 offen offset:0
    buffer_load_dwordx4 v[108:111], v8, s[20:23], s34 offen offset:2048
    s_add_u32 s34, s34, 4096
    buffer_load_dwordx4 v[112:115], v8, s[20:23], s34 offen offset:0
    buffer_load_dwordx4 v[116:119], v8, s[20:23], s34 offen offset:2048
    s_add_u32 s34, s34, 4096
    buffer_load_dwordx4 v[120:123], v8, s[20:23], s34 offen offset:0
    buffer_load_dwordx4 v[124:127], v8, s[20:23], s34 offen offset:2048
    s_lshl_b32 s33, s31, 8
    s_lshl_b32 s34, s32, 3
    s_add_u32 s33, s33, s34
    s_add_u32 s33, s33, 0x200000
    v_lshlrev_b32 v9, 11, v6
    buffer_load_dwordx2 v[128:129], v9, s[20:23], s33 offen offset:0
    buffer_load_dwordx2 v[130:131], v9, s[20:23], s33 offen offset:32
    buffer_load_dwordx2 v[132:133], v9, s[20:23], s33 offen offset:64
    buffer_load_dwordx2 v[134:135], v9, s[20:23], s33 offen offset:96
    buffer_load_dwordx2 v[136:137], v9, s[20:23], s33 offen offset:128
    buffer_load_dwordx2 v[138:139], v9, s[20:23], s33 offen offset:160
    buffer_load_dwordx2 v[140:141], v9, s[20:23], s33 offen offset:192
    buffer_load_dwordx2 v[142:143], v9, s[20:23], s33 offen offset:224
    s_waitcnt vmcnt(0)
    v_max_f32 v10, v128, v130
    v_max3_f32 v10, v10, v132, v134
    v_max3_f32 v10, v10, v136, v138
    v_max3_f32 v10, v10, v140, v142
    v_mov_b32 v11, 0
    v_mov_b32 v12, 0
    v_mov_b32 v13, 0
    v_mov_b32 v14, 0
    v_mov_b32 v15, 0
    v_sub_f32 v16, v128, v10
    v_mul_f32 v16, 0x3fb8aa3b, v16
    v_exp_f32 v16, v16
    s_nop 0
    v_fmac_f32 v11, v16, v129
    v_fmac_f32 v12, v16, v96
    v_fmac_f32 v13, v16, v97
    v_fmac_f32 v14, v16, v98
    v_fmac_f32 v15, v16, v99
    v_sub_f32 v16, v130, v10
    v_mul_f32 v16, 0x3fb8aa3b, v16
    v_exp_f32 v16, v16
    s_nop 0
    v_fmac_f32 v11, v16, v131
    v_fmac_f32 v12, v16, v100
    v_fmac_f32 v13, v16, v101
    v_fmac_f32 v14, v16, v102
    v_fmac_f32 v15, v16, v103
    v_sub_f32 v16, v132, v10
    v_mul_f32 v16, 0x3fb8aa3b, v16
    v_exp_f32 v16, v16
    s_nop 0
    v_fmac_f32 v11, v16, v133
    v_fmac_f32 v12, v16, v104
    v_fmac_f32 v13, v16, v105
    v_fmac_f32 v14, v16, v106
    v_fmac_f32 v15, v16, v107
    v_sub_f32 v16, v134, v10
    v_mul_f32 v16, 0x3fb8aa3b, v16
    v_exp_f32 v16, v16
    s_nop 0
    v_fmac_f32 v11, v16, v135
    v_fmac_f32 v12, v16, v108
    v_fmac_f32 v13, v16, v109
    v_fmac_f32 v14, v16, v110
    v_fmac_f32 v15, v16, v111
    v_sub_f32 v16, v136, v10
    v_mul_f32 v16, 0x3fb8aa3b, v16
    v_exp_f32 v16, v16
    s_nop 0
    v_fmac_f32 v11, v16, v137
    v_fmac_f32 v12, v16, v112
    v_fmac_f32 v13, v16, v113
    v_fmac_f32 v14, v16, v114
    v_fmac_f32 v15, v16, v115
    v_sub_f32 v16, v138, v10
    v_mul_f32 v16, 0x3fb8aa3b, v16
    v_exp_f32 v16, v16
    s_nop 0
    v_fmac_f32 v11, v16, v139
    v_fmac_f32 v12, v16, v116
    v_fmac_f32 v13, v16, v117
    v_fmac_f32 v14, v16, v118
    v_fmac_f32 v15, v16, v119
    v_sub_f32 v16, v140, v10
    v_mul_f32 v16, 0x3fb8aa3b, v16
    v_exp_f32 v16, v16
    s_nop 0
    v_fmac_f32 v11, v16, v141
    v_fmac_f32 v12, v16, v120
    v_fmac_f32 v13, v16, v121
    v_fmac_f32 v14, v16, v122
    v_fmac_f32 v15, v16, v123
    v_sub_f32 v16, v142, v10
    v_mul_f32 v16, 0x3fb8aa3b, v16
    v_exp_f32 v16, v16
    s_nop 0
    v_fmac_f32 v11, v16, v143
    v_fmac_f32 v12, v16, v124
    v_fmac_f32 v13, v16, v125
    v_fmac_f32 v14, v16, v126
    v_fmac_f32 v15, v16, v127
    v_rcp_f32 v16, v11
    s_nop 0
    v_fma_f32 v17, -v11, v16, 1.0
    v_fma_f32 v16, v17, v16, v16
    v_mul_f32 v12, v12, v16
    v_mul_f32 v13, v13, v16
    v_mul_f32 v14, v14, v16
    v_mul_f32 v15, v15, v16
    s_branch K3_pre_done
K3_fpre:
    s_mov_b32 s12, s10
    s_mov_b32 s13, s11
    s_mov_b32 s14, 0xe00
    s_mov_b32 s15, 0x00020000
    s_mov_b32 s36, 7168
    v_mul_lo_u32 v8, v6, s36
    v_lshl_add_u32 v8, v7, 4, v8
    s_lshl_b32 s33, s27, 9
    s_add_u32 s33, s33, 0x80000
    buffer_load_dwordx4 v[96:99], v8, s[20:23], s33 offen
    s_add_u32 s33, s33, 57344
    buffer_load_dwordx4 v[100:103], v8, s[20:23], s33 offen
    s_add_u32 s33, s33, 57344
    buffer_load_dwordx4 v[104:107], v8, s[20:23], s33 offen
    s_add_u32 s33, s33, 57344
    buffer_load_dwordx4 v[108:111], v8, s[20:23], s33 offen
    v_lshlrev_b32 v9, 3, v7
    s_lshl_b32 s33, s27, 8
    buffer_load_dwordx2 v[112:113], v9, s[12:15], s33 offen
    s_waitcnt vmcnt(0)
    v_lshlrev_b32 v114, 16, v112
    v_and_b32 v115, 0xffff0000, v112
    v_lshlrev_b32 v116, 16, v113
    v_and_b32 v117, 0xffff0000, v113
    v_add_f32 v96, v96, v100
    v_add_f32 v104, v104, v108
    v_add_f32 v12, v96, v104
    v_cvt_pk_bf16_f32 v12, v12, v12
    v_lshlrev_b32 v12, 16, v12
    v_add_f32 v12, v12, v114
    v_cvt_pk_bf16_f32 v12, v12, v12
    v_lshlrev_b32 v12, 16, v12
    v_mul_f32 v16, v12, v12
    v_mul_f32 v16, v16, v12
    v_mov_b32 v17, 0x3d372713
    v_fma_f32 v16, v16, v17, v12
    v_mul_f32 v16, 0x3f4c422a, v16
    v_mul_f32 v16, 0x4038aa3b, v16
    v_exp_f32 v16, v16
    s_nop 0
    v_add_f32 v16, 1.0, v16
    v_rcp_f32 v16, v16
    s_nop 0
    v_fma_f32 v16, v16, -2.0, 1.0
    v_add_f32 v16, 1.0, v16
    v_mul_f32 v16, 0.5, v16
    v_mul_f32 v12, v12, v16
    v_add_f32 v97, v97, v101
    v_add_f32 v105, v105, v109
    v_add_f32 v13, v97, v105
    v_cvt_pk_bf16_f32 v13, v13, v13
    v_lshlrev_b32 v13, 16, v13
    v_add_f32 v13, v13, v115
    v_cvt_pk_bf16_f32 v13, v13, v13
    v_lshlrev_b32 v13, 16, v13
    v_mul_f32 v16, v13, v13
    v_mul_f32 v16, v16, v13
    v_mov_b32 v17, 0x3d372713
    v_fma_f32 v16, v16, v17, v13
    v_mul_f32 v16, 0x3f4c422a, v16
    v_mul_f32 v16, 0x4038aa3b, v16
    v_exp_f32 v16, v16
    s_nop 0
    v_add_f32 v16, 1.0, v16
    v_rcp_f32 v16, v16
    s_nop 0
    v_fma_f32 v16, v16, -2.0, 1.0
    v_add_f32 v16, 1.0, v16
    v_mul_f32 v16, 0.5, v16
    v_mul_f32 v13, v13, v16
    v_add_f32 v98, v98, v102
    v_add_f32 v106, v106, v110
    v_add_f32 v14, v98, v106
    v_cvt_pk_bf16_f32 v14, v14, v14
    v_lshlrev_b32 v14, 16, v14
    v_add_f32 v14, v14, v116
    v_cvt_pk_bf16_f32 v14, v14, v14
    v_lshlrev_b32 v14, 16, v14
    v_mul_f32 v16, v14, v14
    v_mul_f32 v16, v16, v14
    v_mov_b32 v17, 0x3d372713
    v_fma_f32 v16, v16, v17, v14
    v_mul_f32 v16, 0x3f4c422a, v16
    v_mul_f32 v16, 0x4038aa3b, v16
    v_exp_f32 v16, v16
    s_nop 0
    v_add_f32 v16, 1.0, v16
    v_rcp_f32 v16, v16
    s_nop 0
    v_fma_f32 v16, v16, -2.0, 1.0
    v_add_f32 v16, 1.0, v16
    v_mul_f32 v16, 0.5, v16
    v_mul_f32 v14, v14, v16
    v_add_f32 v99, v99, v103
    v_add_f32 v107, v107, v111
    v_add_f32 v15, v99, v107
    v_cvt_pk_bf16_f32 v15, v15, v15
    v_lshlrev_b32 v15, 16, v15
    v_add_f32 v15, v15, v117
    v_cvt_pk_bf16_f32 v15, v15, v15
    v_lshlrev_b32 v15, 16, v15
    v_mul_f32 v16, v15, v15
    v_mul_f32 v16, v16, v15
    v_mov_b32 v17, 0x3d372713
    v_fma_f32 v16, v16, v17, v15
    v_mul_f32 v16, 0x3f4c422a, v16
    v_mul_f32 v16, 0x4038aa3b, v16
    v_exp_f32 v16, v16
    s_nop 0
    v_add_f32 v16, 1.0, v16
    v_rcp_f32 v16, v16
    s_nop 0
    v_fma_f32 v16, v16, -2.0, 1.0
    v_add_f32 v16, 1.0, v16
    v_mul_f32 v16, 0.5, v16
    v_mul_f32 v15, v15, v16
K3_pre_done:
    v_cvt_pk_bf16_f32 v12, v12, v13
    v_cvt_pk_bf16_f32 v13, v14, v15
    v_lshlrev_b32 v8, 8, v6
    v_lshl_add_u32 v8, v7, 3, v8
    ds_write_b64 v8, v[12:13]
    s_waitcnt lgkmcnt(0)
    s_barrier
    v_and_b32 v5, 7, v2
    v_lshlrev_b32 v5, 8, v5
    v_lshrrev_b32 v8, 4, v2
    v_lshlrev_b32 v8, 4, v8
    v_add_u32 v5, v5, v8
    s_lshl_b32 s31, s3, 6
    v_add_u32 v5, s31, v5
    ds_read_b128 v[8:11], v5
    s_mov_b32 s32, 0x05040100
    s_mov_b32 s33, 0x07060302
    s_waitcnt vmcnt(0) lgkmcnt(0)
    v_perm_b32 v64, v36, v32, s32
    v_perm_b32 v65, v44, v40, s32
    v_perm_b32 v66, v52, v48, s32
    v_perm_b32 v67, v60, v56, s32
    v_perm_b32 v68, v36, v32, s33
    v_perm_b32 v69, v44, v40, s33
    v_perm_b32 v70, v52, v48, s33
    v_perm_b32 v71, v60, v56, s33
    v_perm_b32 v72, v37, v33, s32
    v_perm_b32 v73, v45, v41, s32
    v_perm_b32 v74, v53, v49, s32
    v_perm_b32 v75, v61, v57, s32
    v_perm_b32 v76, v37, v33, s33
    v_perm_b32 v77, v45, v41, s33
    v_perm_b32 v78, v53, v49, s33
    v_perm_b32 v79, v61, v57, s33
    v_perm_b32 v80, v38, v34, s32
    v_perm_b32 v81, v46, v42, s32
    v_perm_b32 v82, v54, v50, s32
    v_perm_b32 v83, v62, v58, s32
    v_perm_b32 v84, v38, v34, s33
    v_perm_b32 v85, v46, v42, s33
    v_perm_b32 v86, v54, v50, s33
    v_perm_b32 v87, v62, v58, s33
    v_perm_b32 v88, v39, v35, s32
    v_perm_b32 v89, v47, v43, s32
    v_perm_b32 v90, v55, v51, s32
    v_perm_b32 v91, v63, v59, s32
    v_perm_b32 v92, v39, v35, s33
    v_perm_b32 v93, v47, v43, s33
    v_perm_b32 v94, v55, v51, s33
    v_perm_b32 v95, v63, v59, s33
    s_nop 1
    v_mfma_f32_16x16x32_bf16 v[96:99], v[8:11], v[64:67], 0
    v_mfma_f32_16x16x32_bf16 v[100:103], v[8:11], v[68:71], 0
    v_mfma_f32_16x16x32_bf16 v[104:107], v[8:11], v[72:75], 0
    v_mfma_f32_16x16x32_bf16 v[108:111], v[8:11], v[76:79], 0
    v_mfma_f32_16x16x32_bf16 v[112:115], v[8:11], v[80:83], 0
    v_mfma_f32_16x16x32_bf16 v[116:119], v[8:11], v[84:87], 0
    v_mfma_f32_16x16x32_bf16 v[120:123], v[8:11], v[88:91], 0
    v_mfma_f32_16x16x32_bf16 v[124:127], v[8:11], v[92:95], 0
    s_nop 7
    s_nop 1
    v_lshrrev_b32 v5, 4, v2
    v_lshlrev_b32 v5, 11, v5
    v_and_b32 v8, 15, v2
    v_lshlrev_b32 v8, 5, v8
    v_add_u32 v5, v5, v8
    s_lshl_b32 s31, s3, 12
    s_add_u32 s31, s31, 8192
    v_add_u32 v5, s31, v5
    v_cmp_gt_u32 vcc, 32, v2
    s_and_saveexec_b64 s[34:35], vcc
    ds_write_b32 v5, v96 offset:0
    ds_write_b32 v5, v97 offset:512
    ds_write_b32 v5, v98 offset:1024
    ds_write_b32 v5, v99 offset:1536
    ds_write_b32 v5, v100 offset:4
    ds_write_b32 v5, v101 offset:516
    ds_write_b32 v5, v102 offset:1028
    ds_write_b32 v5, v103 offset:1540
    ds_write_b32 v5, v104 offset:8
    ds_write_b32 v5, v105 offset:520
    ds_write_b32 v5, v106 offset:1032
    ds_write_b32 v5, v107 offset:1544
    ds_write_b32 v5, v108 offset:12
    ds_write_b32 v5, v109 offset:524
    ds_write_b32 v5, v110 offset:1036
    ds_write_b32 v5, v111 offset:1548
    ds_write_b32 v5, v112 offset:16
    ds_write_b32 v5, v113 offset:528
    ds_write_b32 v5, v114 offset:1040
    ds_write_b32 v5, v115 offset:1552
    ds_write_b32 v5, v116 offset:20
    ds_write_b32 v5, v117 offset:532
    ds_write_b32 v5, v118 offset:1044
    ds_write_b32 v5, v119 offset:1556
    ds_write_b32 v5, v120 offset:24
    ds_write_b32 v5, v121 offset:536
    ds_write_b32 v5, v122 offset:1048
    ds_write_b32 v5, v123 offset:1560
    ds_write_b32 v5, v124 offset:28
    ds_write_b32 v5, v125 offset:540
    ds_write_b32 v5, v126 offset:1052
    ds_write_b32 v5, v127 offset:1564
    s_mov_b64 exec, s[34:35]
    s_waitcnt lgkmcnt(0)
    s_barrier
    v_lshlrev_b32 v5, 2, v0
    ds_read_b32 v16, v5 offset:8192
    ds_read_b32 v17, v5 offset:12288
    ds_read_b32 v18, v5 offset:16384
    ds_read_b32 v19, v5 offset:20480
    ds_read_b32 v20, v5 offset:9216
    ds_read_b32 v21, v5 offset:13312
    ds_read_b32 v22, v5 offset:17408
    ds_read_b32 v23, v5 offset:21504
    ds_read_b32 v24, v5 offset:10240
    ds_read_b32 v25, v5 offset:14336
    ds_read_b32 v26, v5 offset:18432
    ds_read_b32 v27, v5 offset:22528
    ds_read_b32 v28, v5 offset:11264
    ds_read_b32 v29, v5 offset:15360
    ds_read_b32 v30, v5 offset:19456
    ds_read_b32 v31, v5 offset:23552
    s_waitcnt lgkmcnt(0)
    v_lshrrev_b32 v8, 7, v0
    v_lshlrev_b32 v8, 11, v8
    v_and_b32 v9, 127, v0
    v_lshl_add_u32 v8, v9, 2, v8
    s_lshl_b32 s31, s28, 9
    s_add_u32 s31, s31, s44
    v_add_f32 v16, v16, v17
    v_add_f32 v18, v18, v19
    v_add_f32 v16, v16, v18
    buffer_atomic_add_f32 v16, v8, s[20:23], s31 offen offset:0
    s_add_u32 s31, s31, 4096
    v_add_f32 v20, v20, v21
    v_add_f32 v22, v22, v23
    v_add_f32 v20, v20, v22
    buffer_atomic_add_f32 v20, v8, s[20:23], s31 offen offset:0
    s_add_u32 s31, s31, 4096
    v_add_f32 v24, v24, v25
    v_add_f32 v26, v26, v27
    v_add_f32 v24, v24, v26
    buffer_atomic_add_f32 v24, v8, s[20:23], s31 offen offset:0
    s_add_u32 s31, s31, 4096
    v_add_f32 v28, v28, v29
    v_add_f32 v30, v30, v31
    v_add_f32 v28, v28, v30
    buffer_atomic_add_f32 v28, v8, s[20:23], s31 offen offset:0
K3_done:
    s_endpgm
.globl recurrent_scan__gqa_block_cached__dense_activation_gelu__decode_k4_kernel
.p2align 8
.type recurrent_scan__gqa_block_cached__dense_activation_gelu__decode_k4_kernel,@function
recurrent_scan__gqa_block_cached__dense_activation_gelu__decode_k4_kernel:
    s_cmp_ge_u32 s2, 16
    s_cbranch_scc1 K4_done
    s_load_dwordx2 s[4:5], s[0:1], 0
    s_load_dwordx2 s[6:7], s[0:1], 72
    s_load_dwordx2 s[10:11], s[0:1], 80
    s_load_dwordx2 s[8:9], s[0:1], 96
    s_waitcnt lgkmcnt(0)
    s_mov_b32 s12, s4
    s_mov_b32 s13, s5
    s_mov_b32 s14, 0x2000
    s_mov_b32 s15, 0x00020000
    s_mov_b32 s16, s6
    s_mov_b32 s17, s7
    s_mov_b32 s18, 0x400
    s_mov_b32 s19, 0x00020000
    s_mov_b32 s20, s8
    s_mov_b32 s21, s9
    s_mov_b32 s22, 0x210000
    s_mov_b32 s23, 0x00020000
    s_mov_b32 s24, s10
    s_mov_b32 s25, s11
    s_mov_b32 s26, 0x2000
    s_mov_b32 s27, 0x00020000
    s_lshl_b32 s3, s2, 8
    v_add_u32 v1, s3, v0
    v_lshlrev_b32 v2, 1, v1
    v_lshlrev_b32 v3, 2, v1
    v_and_b32 v4, 511, v1
    v_lshlrev_b32 v4, 1, v4
    buffer_load_ushort v5, v2, s[12:15], 0 offen
    buffer_load_ushort v6, v4, s[16:19], 0 offen
    s_mov_b32 s28, 0xc0000
    s_mov_b32 s29, 0xc4000
    buffer_load_dword v7, v3, s[20:23], s28 offen
    buffer_load_dword v8, v3, s[20:23], s29 offen
    s_waitcnt vmcnt(0)
    v_lshlrev_b32 v5, 16, v5
    v_lshlrev_b32 v6, 16, v6
    v_cvt_pk_bf16_f32 v7, v7, v7
    v_lshlrev_b32 v7, 16, v7
    v_cvt_pk_bf16_f32 v8, v8, v8
    v_lshlrev_b32 v8, 16, v8
    v_add_f32 v8, v8, v6
    v_cvt_pk_bf16_f32 v8, v8, v8
    v_lshlrev_b32 v8, 16, v8
    v_mul_f32 v9, 0xbfb8aa3b, v8
    v_exp_f32 v9, v9
    s_nop 0
    v_add_f32 v9, 1.0, v9
    v_rcp_f32 v10, v9
    s_nop 0
    v_fma_f32 v11, -v9, v10, 1.0
    v_fma_f32 v10, v11, v10, v10
    v_mul_f32 v8, v8, v10
    v_cvt_pk_bf16_f32 v8, v8, v8
    v_lshlrev_b32 v8, 16, v8
    v_mul_f32 v7, v7, v8
    v_cvt_pk_bf16_f32 v7, v7, v7
    v_lshlrev_b32 v7, 16, v7
    v_add_f32 v5, v5, v7
    v_cvt_pk_bf16_f32 v5, v5, v5
    buffer_store_short v5, v2, s[24:27], 0 offen
K4_done:
    s_endpgm
.section .rodata,"a"
.p2align 6
.amdhsa_kernel recurrent_scan__gqa_block_cached__dense_activation_gelu__decode_k1_kernel
  .amdhsa_next_free_vgpr 128
  .amdhsa_next_free_sgpr 102
  .amdhsa_accum_offset 128
  .amdhsa_group_segment_fixed_size 0
  .amdhsa_kernarg_size 104
  .amdhsa_user_sgpr_count 2
  .amdhsa_user_sgpr_kernarg_segment_ptr 1
  .amdhsa_system_sgpr_workgroup_id_x 1
.end_amdhsa_kernel
.p2align 6
.amdhsa_kernel recurrent_scan__gqa_block_cached__dense_activation_gelu__decode_k2_kernel
  .amdhsa_next_free_vgpr 248
  .amdhsa_next_free_sgpr 102
  .amdhsa_accum_offset 248
  .amdhsa_group_segment_fixed_size 0
  .amdhsa_kernarg_size 104
  .amdhsa_user_sgpr_count 2
  .amdhsa_user_sgpr_kernarg_segment_ptr 1
  .amdhsa_system_sgpr_workgroup_id_x 1
.end_amdhsa_kernel
.p2align 6
.amdhsa_kernel recurrent_scan__gqa_block_cached__dense_activation_gelu__decode_k3_kernel
  .amdhsa_next_free_vgpr 144
  .amdhsa_next_free_sgpr 102
  .amdhsa_accum_offset 144
  .amdhsa_group_segment_fixed_size 0
  .amdhsa_kernarg_size 104
  .amdhsa_user_sgpr_count 2
  .amdhsa_user_sgpr_kernarg_segment_ptr 1
  .amdhsa_system_sgpr_workgroup_id_x 1
.end_amdhsa_kernel
.p2align 6
.amdhsa_kernel recurrent_scan__gqa_block_cached__dense_activation_gelu__decode_k4_kernel
  .amdhsa_next_free_vgpr 32
  .amdhsa_next_free_sgpr 102
  .amdhsa_accum_offset 32
  .amdhsa_group_segment_fixed_size 0
  .amdhsa_kernarg_size 104
  .amdhsa_user_sgpr_count 2
  .amdhsa_user_sgpr_kernarg_segment_ptr 1
  .amdhsa_system_sgpr_workgroup_id_x 1
.end_amdhsa_kernel
```
